```python
import torch

def _softmax(x, axis=-1):
    return torch.softmax(x, dim=axis)
def _gelu(x):
    return torch.nn.functional.gelu(x, approximate="tanh")
def _silu(x):
    return torch.nn.functional.silu(x)
def _sigmoid(x):
    return torch.sigmoid(x)
def _layernorm(x, axis=-1, eps=1e-5):
    m = x.mean(dim=axis, keepdim=True)
    v = x.var(dim=axis, keepdim=True, unbiased=False)
    return (x - m) / torch.sqrt(v + eps)
def _scatter_add(tgt, idx, src, axis=0):
    return tgt.clone().index_add_(axis, idx, src)
def _segment_sum(src, seg, n):
    out = torch.zeros((n,) + src.shape[1:], dtype=src.dtype)
    return out.index_add_(0, seg, src)
def _pad(x, pw):
    flat = tuple(v for pair in reversed(pw) for v in pair)
    return torch.nn.functional.pad(x, flat)

kernel_name = 'interleave_layers__linear_attn_block__sliding_block__prompt'

def setup_inputs():

    _w = (lambda a: (lambda t: t.to(torch.bfloat16) if t.is_floating_point() else t)(torch.as_tensor(a)))
    def _A_setup():
        B, S, D = 1, 2048, 640
        return {
            "x": _w((lambda *s: torch.randn(*s, dtype=torch.bfloat16) * 0.05)(B, S, D)),
            "wqkv": _w((lambda *s: torch.randn(*s, dtype=torch.bfloat16) * 0.05)(D, 3 * D)),
            "wo": _w((lambda *s: torch.randn(*s, dtype=torch.bfloat16) * 0.05)(D, D)),
        }
    _A_in = _A_setup()

    def _B_setup():
        B, S, D = 1, 2048, 640
        return {
            "x": _w((lambda *s: torch.randn(*s, dtype=torch.bfloat16) * 0.05)(B, S, D)),
            "wqkv": _w((lambda *s: torch.randn(*s, dtype=torch.bfloat16) * 0.05)(D, 3 * D)),
            "wo": _w((lambda *s: torch.randn(*s, dtype=torch.bfloat16) * 0.1)(D, D)),
        }
    _B_in = _B_setup()

    return {
        "A_x": _A_in["x"],
        "A_wqkv": _A_in["wqkv"],
        "A_wo": _A_in["wo"],
        "B_x": _B_in["x"],
        "B_wqkv": _B_in["wqkv"],
        "B_wo": _B_in["wo"],
    }

def reference(A_x, A_wqkv, A_wo, B_x, B_wqkv, B_wo):
    def _A_ref(x, wqkv, wo):
        B, S, D = x.shape
        H = 32; Dh = D // H
        qkv = (lambda x, *d: x.permute(*d))((x @ wqkv).reshape(B, S, 3, H, Dh), 2, 0, 3, 1, 4)
        q, k, v = qkv[0], qkv[1], qkv[2]
        phi = lambda t: torch.where(t > 0, t + 1, torch.exp(t)) + 1e-6
        pq, pk = phi(q), phi(k)
        kv = torch.einsum("bhsd,bhse->bhde", pk, v)
        z = torch.einsum("bhsd->bhd", pk)
        num = torch.einsum("bhqd,bhde->bhqe", pq, kv)
        den = torch.einsum("bhqd,bhd->bhq", pq, z)[..., None] + 1e-6
        o = num / den
        return (lambda x, *d: x.permute(*d))(o, 0, 2, 1, 3).reshape(B, S, D) @ wo

    def _B_ref(x, wqkv, wo):
        B, S, D = x.shape
        H = 32; Dh = D // H; W = 256
        qkv = (lambda x, *d: x.permute(*d))((x @ wqkv).reshape(B, S, 3, H, Dh), 2, 0, 3, 1, 4)
        q, k, v = qkv[0], qkv[1], qkv[2]
        scores = torch.einsum("bhqd,bhkd->bhqk", q, k) * (Dh ** -0.5)
        idx = torch.arange(S)
        mask = (idx[:, None] - idx[None, :] >= 0) & (idx[:, None] - idx[None, :] < W)
        scores = torch.where(mask[None, None], scores, -1e9)
        p = _softmax(scores, axis=-1)
        o = torch.einsum("bhqk,bhkd->bhqd", p, v)
        return (lambda x, *d: x.permute(*d))(o, 0, 2, 1, 3).reshape(B, S, D) @ wo

    x = A_x
    x = x + _A_ref(_layernorm(x, axis=-1), A_wqkv, A_wo)
    x = x + _B_ref(_layernorm(x, axis=-1), B_wqkv, B_wo)
    x = x + _A_ref(_layernorm(x, axis=-1), A_wqkv, A_wo)
    x = x + _B_ref(_layernorm(x, axis=-1), B_wqkv, B_wo)
    return x
```

```asm
; @launch kernel=prep_kernel grid=(448,1,1) block=(256,1,1) lds=21504
; @launch kernel=main_kernel grid=(256,1,1) block=(256,1,1) lds=163840
.amdgcn_target "amdgcn-amd-amdhsa--gfx950"
.text
.globl prep_kernel
.p2align 8
.type prep_kernel,@function
prep_kernel:
  s_cmp_ge_u32 s2, 448
  s_cbranch_scc1 K0_end
  s_load_dwordx2 s[4:5], s[0:1], 64
  s_load_dwordx4 s[16:19], s[0:1], 0
  s_load_dwordx2 s[20:21], s[0:1], 16
  s_load_dwordx4 s[24:27], s[0:1], 32
  v_and_b32 v1, 63, v0
  v_lshrrev_b32 v2, 6, v0
  s_nop 0
  v_readfirstlane_b32 s3, v2
  s_waitcnt lgkmcnt(0)
  s_mov_b32 s12, s4
  s_and_b32 s13, s5, 0xffff
  s_mov_b32 s14, 44351488
  s_mov_b32 s15, 0x20000
  s_cmp_ge_u32 s2, 320
  s_cbranch_scc1 K0_x
  s_and_b32 s43, s2, 1
  s_lshr_b32 s44, s2, 1
  s_mov_b32 s79, s43
  s_cmp_ge_u32 s44, 120
  s_cbranch_scc1 K0_wo_setup
  s_cmp_ge_u32 s44, 60
  s_cselect_b32 s30, 1, 0
  s_mul_i32 s31, s30, 60
  s_sub_u32 s31, s44, s31
  s_mul_i32 s32, s31, 86
  s_lshr_b32 s32, s32, 8
  s_mul_i32 s33, s32, 3
  s_sub_u32 s33, s31, s33
  s_cmp_eq_u32 s30, 0
  s_cselect_b32 s8, s18, s24
  s_cselect_b32 s9, s19, s25
  s_and_b32 s9, s9, 0xffff
  s_mov_b32 s10, 2457600
  s_mov_b32 s11, 0x20000
  s_mov_b32 s34, 3840
  s_mul_i32 s35, s33, 1280
  s_mov_b32 s36, 0
  s_lshr_b32 s37, s32, 1
  s_mul_i32 s37, s37, 10
  s_and_b32 s38, s32, 1
  s_lshl_b32 s38, s38, 2
  s_add_u32 s37, s37, s38
  s_add_u32 s37, s37, s3
  s_sub_u32 s38, s32, 16
  s_mul_i32 s38, s38, 20
  s_lshr_b32 s39, s3, 1
  s_mul_i32 s39, s39, 10
  s_add_u32 s38, s38, s39
  s_and_b32 s39, s3, 1
  s_add_u32 s38, s38, s39
  s_add_u32 s38, s38, 8
  s_cmp_lt_u32 s32, 16
  s_cselect_b32 s37, s37, s38
  s_lshl_b32 s37, s37, 3
  s_mov_b32 s40, 0
  s_branch K0_load
K0_wo_setup:
  s_sub_u32 s31, s44, 120
  s_cmp_ge_u32 s31, 20
  s_cselect_b32 s30, 1, 0
  s_mul_i32 s32, s30, 20
  s_sub_u32 s32, s31, s32
  s_cmp_eq_u32 s30, 0
  s_cselect_b32 s8, s20, s26
  s_cselect_b32 s9, s21, s27
  s_and_b32 s9, s9, 0xffff
  s_mov_b32 s10, 819200
  s_mov_b32 s11, 0x20000
  s_mov_b32 s34, 1280
  s_mov_b32 s35, 0
  s_mov_b32 s36, 16
  s_mul_i32 s37, s32, 40
  s_lshl_b32 s38, s3, 2
  s_add_u32 s37, s37, s38
  s_sub_u32 s38, s32, 16
  s_lshl_b32 s38, s38, 2
  s_add_u32 s38, s38, s3
  s_mul_i32 s38, s38, 40
  s_add_u32 s38, s38, 16
  s_cmp_lt_u32 s32, 16
  s_cselect_b32 s37, s37, s38
  s_mov_b32 s40, 1
K0_load:
  v_lshrrev_b32 v2, 3, v1
  v_and_b32 v3, 7, v1
  v_lshlrev_b32 v3, 4, v3
  v_cmp_le_u32 vcc, 4, v2
  v_mov_b32 v6, s36
  s_nop 0
  v_cndmask_b32_e64 v5, 0, v6, vcc
  v_add3_u32 v4, v5, v2, s37
  v_mul_lo_u32 v4, v4, s34
  s_mul_i32 s42, s79, 640
  s_add_u32 s42, s42, s35
  v_add3_u32 v4, v4, v3, s42
  buffer_load_dwordx4 v[40:43], v4, s[8:11], 0 offen offset:0 nt
  buffer_load_dwordx4 v[44:47], v4, s[8:11], 0 offen offset:128 nt
  buffer_load_dwordx4 v[48:51], v4, s[8:11], 0 offen offset:256 nt
  buffer_load_dwordx4 v[52:55], v4, s[8:11], 0 offen offset:384 nt
  buffer_load_dwordx4 v[56:59], v4, s[8:11], 0 offen offset:512 nt
  s_mul_i32 s41, s3, 5376
  v_mul_u32_u24 v5, 672, v2
  v_add3_u32 v5, v5, v3, s41
  s_waitcnt vmcnt(4)
  ds_write_b128 v5, v[40:43] offset:0
  s_waitcnt vmcnt(3)
  ds_write_b128 v5, v[44:47] offset:128
  s_waitcnt vmcnt(2)
  ds_write_b128 v5, v[48:51] offset:256
  s_waitcnt vmcnt(1)
  ds_write_b128 v5, v[52:55] offset:384
  s_waitcnt vmcnt(0)
  ds_write_b128 v5, v[56:59] offset:512
  s_waitcnt lgkmcnt(0)
  s_barrier
  v_lshrrev_b32 v2, 4, v1
  v_and_b32 v3, 15, v1
  v_lshrrev_b32 v4, 2, v3
  v_and_b32 v5, 3, v1
  v_lshl_add_u32 v6, v2, 3, v4
  v_mul_u32_u24 v6, 672, v6
  s_mul_i32 s42, s3, 160
  v_add_u32 v6, s42, v6
  v_lshlrev_b32 v7, 4, v1
  v_mov_b32 v8, 0x3f803f80
  v_mov_b32 v9, v8
  v_mov_b32 v10, v8
  v_mov_b32 v11, v8
  s_cmp_eq_u32 s40, 1
  s_cbranch_scc1 K0_wo_out
  s_mul_i32 s43, s30, 3
  s_add_u32 s43, s43, s33
  s_mul_i32 s50, s32, 5120
  s_mul_i32 s51, s32, 2560
  s_add_u32 s51, s51, 102400
  s_mul_i32 s52, s32, 3072
  s_mul_i32 s78, s32, 2560
  s_add_u32 s78, s78, 61440
  s_lshl_b32 s53, s32, 11
  s_add_u32 s53, s53, 112640
  s_cmp_lg_u32 s43, 0
  s_cbranch_scc1 K0_case0_done
  s_add_u32 s44, s51, 0
  s_add_u32 s45, s51, 1024
  s_add_u32 s46, s51, 2048
  s_mov_b32 s47, 320
  s_mov_b32 s48, 384
  s_mov_b32 s49, 448
  s_mov_b32 s54, 2
K0_case0_done:
  s_cmp_lg_u32 s43, 1
  s_cbranch_scc1 K0_case1_done
  s_add_u32 s44, s50, 0
  s_add_u32 s45, s50, 1024
  s_add_u32 s46, s50, 4096
  s_mov_b32 s47, 0
  s_mov_b32 s48, 64
  s_mov_b32 s49, 256
  s_mov_b32 s54, 0
K0_case1_done:
  s_cmp_lg_u32 s43, 2
  s_cbranch_scc1 K0_case2_done
  s_add_u32 s44, s50, 2048
  s_add_u32 s45, s50, 3072
  s_add_u32 s46, s50, 4096
  s_mov_b32 s47, 128
  s_mov_b32 s48, 192
  s_mov_b32 s49, 256
  s_mov_b32 s54, 1
K0_case2_done:
  s_cmp_lg_u32 s43, 3
  s_cbranch_scc1 K0_case3_done
  s_add_u32 s44, s53, 0
  s_add_u32 s45, s53, 1024
  s_add_u32 s46, s52, 2048
  s_mov_b32 s47, 384
  s_mov_b32 s48, 448
  s_mov_b32 s49, 128
  s_mov_b32 s54, 1
K0_case3_done:
  s_cmp_lg_u32 s43, 4
  s_cbranch_scc1 K0_case4_done
  s_add_u32 s44, s52, 0
  s_add_u32 s45, s52, 1024
  s_add_u32 s46, s52, 2048
  s_mov_b32 s47, 0
  s_mov_b32 s48, 64
  s_mov_b32 s49, 128
  s_mov_b32 s54, 0
K0_case4_done:
  s_cmp_lg_u32 s43, 5
  s_cbranch_scc1 K0_case5_done
  s_add_u32 s44, s78, 0
  s_add_u32 s45, s78, 1024
  s_add_u32 s46, s78, 2048
  s_mov_b32 s47, 192
  s_mov_b32 s48, 256
  s_mov_b32 s49, 320
  s_mov_b32 s54, 2
K0_case5_done:
  v_cmp_gt_u32 s[56:57], 8, v3
  s_nop 0
  s_not_b64 s[60:61], s[56:57]
  s_cmp_eq_u32 s54, 1
  s_cselect_b64 s[58:59], s[60:61], s[56:57]
  v_lshlrev_b32 v12, 7, v2
  v_lshl_add_u32 v12, v3, 4, v12
  s_cmp_eq_u32 s54, 2
  s_cselect_b64 s[62:63], -1, 0
  v_cndmask_b32_e64 v12, v7, v12, s[62:63]
  v_lshl_add_u32 v13, v5, 3, v6
  v_and_b32 v14, 1, v5
  v_mul_u32_u24 v14, 40, v14
  v_add3_u32 v14, v14, v6, 32
  s_mul_i32 s64, s30, 2457600
  s_lshl_b32 s65, s79, 3
  s_lshl_b32 s80, s3, 1
  s_add_u32 s80, s80, s65
  s_mul_i32 s65, s80, 153600
  s_add_u32 s64, s64, s65
  s_mul_i32 s66, s30, 163840
  s_lshl_b32 s67, s32, 13
  s_add_u32 s66, s66, s67
  s_lshl_b32 s67, s80, 9
  s_add_u32 s66, s66, s67
  s_add_u32 s66, s66, 6553600
  v_lshlrev_b32 v15, 2, v3
  ds_read_b64_tr_b16 v[40:41], v13 offset:0
  ds_read_b64_tr_b16 v[42:43], v13 offset:2688
  ds_read_b64_tr_b16 v[44:45], v13 offset:40
  ds_read_b64_tr_b16 v[46:47], v13 offset:2728
  ds_read_b64_tr_b16 v[48:49], v14 offset:0
  ds_read_b64_tr_b16 v[50:51], v14 offset:2688
  ds_read_b64_tr_b16 v[52:53], v13 offset:80
  ds_read_b64_tr_b16 v[54:55], v13 offset:2768
  ds_read_b64_tr_b16 v[56:57], v13 offset:120
  ds_read_b64_tr_b16 v[58:59], v13 offset:2808
  ds_read_b64_tr_b16 v[60:61], v14 offset:80
  ds_read_b64_tr_b16 v[62:63], v14 offset:2768
  s_waitcnt lgkmcnt(0)
  v_mfma_f32_16x16x32_bf16 v[100:103], v[8:11], v[40:43], 0
  v_mfma_f32_16x16x32_bf16 v[104:107], v[8:11], v[44:47], 0
  v_mfma_f32_16x16x32_bf16 v[108:111], v[8:11], v[48:51], 0
  v_mfma_f32_16x16x32_bf16 v[112:115], v[8:11], v[52:55], 0
  v_mfma_f32_16x16x32_bf16 v[116:119], v[8:11], v[56:59], 0
  v_mfma_f32_16x16x32_bf16 v[120:123], v[8:11], v[60:63], 0
  s_add_u32 s68, s64, 0
  s_add_u32 s69, s68, s44
  buffer_store_dwordx4 v[40:43], v7, s[12:15], s69 offen sc1
  s_add_u32 s69, s68, s45
  buffer_store_dwordx4 v[44:47], v7, s[12:15], s69 offen sc1
  s_add_u32 s69, s68, s46
  s_mov_b64 exec, s[58:59]
  buffer_store_dwordx4 v[48:51], v12, s[12:15], s69 offen sc1
  s_mov_b64 exec, -1
  s_add_u32 s68, s64, 153600
  s_add_u32 s69, s68, s44
  buffer_store_dwordx4 v[52:55], v7, s[12:15], s69 offen sc1
  s_add_u32 s69, s68, s45
  buffer_store_dwordx4 v[56:59], v7, s[12:15], s69 offen sc1
  s_add_u32 s69, s68, s46
  s_mov_b64 exec, s[58:59]
  buffer_store_dwordx4 v[60:63], v12, s[12:15], s69 offen sc1
  s_mov_b64 exec, -1
  v_lshlrev_b32 v16, 9, v2
  v_add_u32 v16, v16, v15
  v_cmp_eq_u32 s[70:71], 1, v2
  s_mov_b32 s72, -1
  s_mov_b32 s73, 0
  s_and_b64 s[74:75], s[72:73], s[58:59]
  s_mov_b64 exec, -1
  v_cndmask_b32_e64 v17, v100, v112, s[70:71]
  s_add_u32 s69, s66, s47
  s_mov_b64 exec, s[72:73]
  buffer_store_dword v17, v16, s[12:15], s69 offen sc1
  s_mov_b64 exec, -1
  v_cndmask_b32_e64 v17, v104, v116, s[70:71]
  s_add_u32 s69, s66, s48
  s_mov_b64 exec, s[72:73]
  buffer_store_dword v17, v16, s[12:15], s69 offen sc1
  s_mov_b64 exec, -1
  v_cndmask_b32_e64 v17, v108, v120, s[70:71]
  s_add_u32 s69, s66, s49
  s_mov_b64 exec, s[74:75]
  buffer_store_dword v17, v16, s[12:15], s69 offen sc1
  s_mov_b64 exec, -1
  s_branch K0_end
K0_wo_out:
  v_lshl_add_u32 v13, v5, 4, v6
  v_lshl_add_u32 v14, v5, 3, v6
  s_mul_i32 s64, s30, 819200
  s_lshl_b32 s65, s79, 2
  s_add_u32 s65, s65, s3
  s_mul_i32 s65, s65, 102400
  s_add_u32 s64, s64, s65
  s_mul_i32 s65, s32, 5120
  s_add_u32 s64, s64, s65
  s_add_u32 s64, s64, 4915200
  ds_read_b64_tr_b16 v[40:41], v13 offset:0
  ds_read_b64_tr_b16 v[42:43], v13 offset:2688
  ds_read_b64_tr_b16 v[44:45], v13 offset:8
  ds_read_b64_tr_b16 v[46:47], v13 offset:2696
  ds_read_b64_tr_b16 v[48:49], v13 offset:64
  ds_read_b64_tr_b16 v[50:51], v13 offset:2752
  ds_read_b64_tr_b16 v[52:53], v13 offset:72
  ds_read_b64_tr_b16 v[54:55], v13 offset:2760
  ds_read_b64_tr_b16 v[56:57], v14 offset:128
  ds_read_b64_tr_b16 v[58:59], v14 offset:2816
  s_waitcnt lgkmcnt(0)
  s_add_u32 s69, s64, 0
  buffer_store_dwordx4 v[40:43], v7, s[12:15], s69 offen sc1
  s_add_u32 s69, s64, 1024
  buffer_store_dwordx4 v[44:47], v7, s[12:15], s69 offen sc1
  s_add_u32 s69, s64, 2048
  buffer_store_dwordx4 v[48:51], v7, s[12:15], s69 offen sc1
  s_add_u32 s69, s64, 3072
  buffer_store_dwordx4 v[52:55], v7, s[12:15], s69 offen sc1
  s_add_u32 s69, s64, 4096
  buffer_store_dwordx4 v[56:59], v7, s[12:15], s69 offen sc1
  s_branch K0_end
K0_x:
  s_mov_b32 s8, s16
  s_and_b32 s9, s17, 0xffff
  s_mov_b32 s10, 2621440
  s_mov_b32 s11, 0x20000
  s_sub_u32 s30, s2, 320
  v_and_b32 v3, 15, v1
  v_lshrrev_b32 v2, 4, v1
  s_mul_i32 s31, s30, 20480
  s_mul_i32 s32, s3, 5120
  s_add_u32 s31, s31, s32
  v_mul_u32_u24 v4, 1280, v2
  v_lshl_add_u32 v4, v3, 4, v4
  buffer_load_dwordx4 v[20:23], v4, s[8:11], s31 offen offset:0 nt
  buffer_load_dwordx4 v[24:27], v4, s[8:11], s31 offen offset:256 nt
  buffer_load_dwordx4 v[28:31], v4, s[8:11], s31 offen offset:512 nt
  buffer_load_dwordx4 v[32:35], v4, s[8:11], s31 offen offset:768 nt
  buffer_load_dwordx4 v[36:39], v4, s[8:11], s31 offen offset:1024 nt
  s_mul_i32 s32, s3, 5184
  v_mul_u32_u24 v5, 1296, v2
  v_lshl_add_u32 v5, v3, 4, v5
  v_add_u32 v5, s32, v5
  v_mul_u32_u24 v40, 1296, v3
  v_lshl_add_u32 v41, v2, 4, v40
  v_lshrrev_b32 v6, 1, v2
  v_mul_u32_u24 v6, 160, v6
  v_and_b32 v7, 1, v2
  v_lshlrev_b32 v7, 4, v7
  v_add3_u32 v6, v6, v7, v40
  v_add_u32 v40, 128, v6
  s_mul_i32 s33, s30, 1920
  s_add_u32 s33, s33, 28377088
  v_lshlrev_b32 v14, 4, v0
  v_mov_b32 v8, 0
  v_mov_b32 v9, 0
  v_mov_b32 v10, 0
  v_mov_b32 v11, 0
  v_cmp_gt_u32 vcc, 120, v0
  s_nop 0
  s_and_saveexec_b64 s[40:41], vcc
  s_cbranch_execz K0_nozero
  buffer_store_dwordx4 v[8:11], v14, s[12:15], s33 offen sc1
K0_nozero:
  s_mov_b64 exec, -1
  v_lshlrev_b32 v15, 4, v1
  s_mul_i32 s33, s3, 131072
  s_lshl_b32 s34, s30, 10
  s_add_u32 s33, s33, s34
  s_add_u32 s33, s33, 43302912
  buffer_store_dwordx4 v[8:11], v15, s[12:15], s33 offen sc1
  s_cmp_ge_u32 s3, 2
  s_cbranch_scc1 K0_nohf
  s_lshl_b32 s33, s30, 11
  s_lshl_b32 s35, s3, 10
  s_add_u32 s33, s33, s35
  s_add_u32 s33, s33, 43827200
  buffer_store_dwordx4 v[8:11], v15, s[12:15], s33 offen sc1
K0_nohf:
  s_cmp_eq_u32 s3, 0
  s_cbranch_scc1 K0_nosent
  v_mov_b32 v16, -1
  v_mov_b32 v17, -1
  v_mov_b32 v18, -1
  v_mov_b32 v19, -1
  s_mul_i32 s33, s3, 131072
  s_add_u32 s33, s33, s34
  s_add_u32 s33, s33, 27852800
  buffer_store_dwordx4 v[16:19], v15, s[12:15], s33 offen sc1
K0_nosent:
  v_lshlrev_b32 v7, 4, v1
  s_mul_i32 s31, s30, 20480
  s_mul_i32 s32, s3, 5120
  s_add_u32 s31, s31, s32
  s_add_u32 s31, s31, 6881280
  v_mov_b32 v8, 0x3f803f80
  v_mov_b32 v9, 0
  v_mov_b32 v10, 0
  v_mov_b32 v11, 0
  v_mov_b32 v12, 0
  s_waitcnt vmcnt(0)
  ds_write_b128 v5, v[20:23] offset:0
  ds_write_b128 v5, v[24:27] offset:256
  ds_write_b128 v5, v[28:31] offset:512
  ds_write_b128 v5, v[32:35] offset:768
  ds_write_b128 v5, v[36:39] offset:1024
  s_waitcnt lgkmcnt(0)
  s_barrier
  s_cmp_lg_u32 s3, 0
  s_cbranch_scc1 K0_xr0
  ds_read_b128 v[20:23], v41 offset:0
  ds_read_b128 v[24:27], v41 offset:64
  ds_read_b128 v[28:31], v41 offset:160
  ds_read_b128 v[32:35], v41 offset:224
  ds_read_b128 v[36:39], v41 offset:320
K0_xr0:
  s_cmp_lg_u32 s3, 1
  s_cbranch_scc1 K0_xr1
  ds_read_b128 v[20:23], v41 offset:384
  ds_read_b128 v[24:27], v41 offset:480
  ds_read_b128 v[28:31], v41 offset:544
  ds_read_b128 v[32:35], v41 offset:640
  ds_read_b128 v[36:39], v41 offset:704
K0_xr1:
  s_cmp_lg_u32 s3, 2
  s_cbranch_scc1 K0_xr2
  ds_read_b128 v[20:23], v41 offset:800
  ds_read_b128 v[24:27], v41 offset:864
  ds_read_b128 v[28:31], v41 offset:960
  ds_read_b128 v[32:35], v41 offset:1024
  ds_read_b128 v[36:39], v41 offset:1120
K0_xr2:
  s_cmp_lg_u32 s3, 3
  s_cbranch_scc1 K0_xr3
  ds_read_b128 v[20:23], v41 offset:1184
  ds_read_b128 v[24:27], v40 offset:0
  ds_read_b128 v[28:31], v40 offset:320
  ds_read_b128 v[32:35], v40 offset:640
  ds_read_b128 v[36:39], v40 offset:960
K0_xr3:
  s_waitcnt lgkmcnt(0)
  buffer_store_dwordx4 v[20:23], v7, s[12:15], s31 offen sc1
  s_add_u32 s31, s31, 1024
  buffer_store_dwordx4 v[24:27], v7, s[12:15], s31 offen sc1
  s_add_u32 s31, s31, 1024
  buffer_store_dwordx4 v[28:31], v7, s[12:15], s31 offen sc1
  s_add_u32 s31, s31, 1024
  buffer_store_dwordx4 v[32:35], v7, s[12:15], s31 offen sc1
  s_add_u32 s31, s31, 1024
  buffer_store_dwordx4 v[36:39], v7, s[12:15], s31 offen sc1
  s_add_u32 s31, s31, 1024
  v_dot2_f32_bf16 v10, v20, v8, v10
  v_dot2_f32_bf16 v12, v20, v20, v12
  v_dot2_f32_bf16 v9, v21, v8, v9
  v_dot2_f32_bf16 v11, v21, v21, v11
  v_dot2_f32_bf16 v10, v22, v8, v10
  v_dot2_f32_bf16 v12, v22, v22, v12
  v_dot2_f32_bf16 v9, v23, v8, v9
  v_dot2_f32_bf16 v11, v23, v23, v11
  v_dot2_f32_bf16 v10, v24, v8, v10
  v_dot2_f32_bf16 v12, v24, v24, v12
  v_dot2_f32_bf16 v9, v25, v8, v9
  v_dot2_f32_bf16 v11, v25, v25, v11
  v_dot2_f32_bf16 v10, v26, v8, v10
  v_dot2_f32_bf16 v12, v26, v26, v12
  v_dot2_f32_bf16 v9, v27, v8, v9
  v_dot2_f32_bf16 v11, v27, v27, v11
  v_dot2_f32_bf16 v10, v28, v8, v10
  v_dot2_f32_bf16 v12, v28, v28, v12
  v_dot2_f32_bf16 v9, v29, v8, v9
  v_dot2_f32_bf16 v11, v29, v29, v11
  v_dot2_f32_bf16 v10, v30, v8, v10
  v_dot2_f32_bf16 v12, v30, v30, v12
  v_dot2_f32_bf16 v9, v31, v8, v9
  v_dot2_f32_bf16 v11, v31, v31, v11
  v_dot2_f32_bf16 v10, v32, v8, v10
  v_dot2_f32_bf16 v12, v32, v32, v12
  v_dot2_f32_bf16 v9, v33, v8, v9
  v_dot2_f32_bf16 v11, v33, v33, v11
  v_dot2_f32_bf16 v10, v34, v8, v10
  v_dot2_f32_bf16 v12, v34, v34, v12
  v_dot2_f32_bf16 v9, v35, v8, v9
  v_dot2_f32_bf16 v11, v35, v35, v11
  v_dot2_f32_bf16 v10, v36, v8, v10
  v_dot2_f32_bf16 v12, v36, v36, v12
  v_dot2_f32_bf16 v9, v37, v8, v9
  v_dot2_f32_bf16 v11, v37, v37, v11
  v_dot2_f32_bf16 v10, v38, v8, v10
  v_dot2_f32_bf16 v12, v38, v38, v12
  v_dot2_f32_bf16 v9, v39, v8, v9
  v_dot2_f32_bf16 v11, v39, v39, v11
  s_nop 1
  v_add_f32 v9, v9, v10
  v_add_f32 v11, v11, v12
  v_mov_b32 v10, v9
  s_nop 1
  v_permlane32_swap_b32 v9, v10
  v_add_f32 v9, v9, v10
  v_mov_b32 v10, v9
  s_nop 1
  v_permlane16_swap_b32 v9, v10
  v_add_f32 v9, v9, v10
  v_mov_b32 v12, v11
  s_nop 1
  v_permlane32_swap_b32 v11, v12
  v_add_f32 v11, v11, v12
  v_mov_b32 v12, v11
  s_nop 1
  v_permlane16_swap_b32 v11, v12
  v_add_f32 v11, v11, v12
  v_cmp_eq_u32 s[40:41], 0, v2
  s_nop 1
  v_cndmask_b32_e64 v12, 0, v9, s[40:41]
  v_cndmask_b32_e64 v13, 0, v11, s[40:41]
  v_lshlrev_b32 v4, 3, v3
  v_lshl_add_u32 v4, v2, 9, v4
  s_lshl_b32 s31, s30, 10
  s_lshl_b32 s32, s3, 7
  s_add_u32 s31, s31, s32
  s_add_u32 s31, s31, 27852800
  s_mov_b32 exec_lo, -1
  s_mov_b32 exec_hi, 0
  buffer_store_dwordx2 v[12:13], v4, s[12:15], s31 offen sc1
K0_end:
  s_endpgm
.globl main_kernel
.p2align 8
.type main_kernel,@function
main_kernel:
  s_cmp_ge_u32 s2, 256
  s_cbranch_scc1 MAIN_end
  s_load_dwordx2 s[4:5], s[0:1], 64
  s_load_dwordx2 s[6:7], s[0:1], 0
  s_load_dwordx2 s[38:39], s[0:1], 48
  v_and_b32 v1, 63, v0
  v_lshrrev_b32 v2, 6, v0
  s_nop 0
  v_readfirstlane_b32 s3, v2
  s_bfe_u32 s20, s2, 0x20001
  s_lshl_b32 s20, s20, 2
  s_bfe_u32 s60, s2, 0x20003
  s_add_u32 s20, s20, s60
  s_and_b32 s21, s2, 1
  s_lshl_b32 s21, s21, 3
  s_lshr_b32 s60, s2, 5
  s_add_u32 s21, s21, s60
  s_lshr_b32 s22, s21, 1
  s_and_b32 s23, s21, 1
  s_mul_i32 s30, s21, 153600
  s_add_u32 s31, s30, 2457600
  s_mul_i32 s32, s22, 102400
  s_add_u32 s33, s32, 5734400
  s_add_u32 s32, s32, 4915200
  v_lshlrev_b32 v2, 4, v1
  s_waitcnt lgkmcnt(0)
  s_mov_b32 s8, s4
  s_and_b32 s9, s5, 0xffff
  s_mov_b32 s10, 44351488
  s_mov_b32 s11, 0x20000
  s_mul_i32 s35, s3, 13
  s_min_u32 s35, s35, 37
  s_lshl_b32 s35, s35, 10
  s_add_u32 s34, s30, s35
  s_add_u32 s35, s35, 51200
  s_mov_b32 m0, s35
  s_nop 0
  buffer_load_dwordx4 v2, s[8:11], s34 offen offset:0 lds
  buffer_load_dwordx4 v2, s[8:11], s34 offen offset:1024 lds
  buffer_load_dwordx4 v2, s[8:11], s34 offen offset:2048 lds
  buffer_load_dwordx4 v2, s[8:11], s34 offen offset:3072 lds
  s_add_u32 s35, s35, 4096
  s_add_u32 s34, s34, 4096
  s_mov_b32 m0, s35
  s_nop 0
  buffer_load_dwordx4 v2, s[8:11], s34 offen offset:0 lds
  buffer_load_dwordx4 v2, s[8:11], s34 offen offset:1024 lds
  buffer_load_dwordx4 v2, s[8:11], s34 offen offset:2048 lds
  buffer_load_dwordx4 v2, s[8:11], s34 offen offset:3072 lds
  s_add_u32 s35, s35, 4096
  s_add_u32 s34, s34, 4096
  s_mov_b32 m0, s35
  s_nop 0
  buffer_load_dwordx4 v2, s[8:11], s34 offen offset:0 lds
  buffer_load_dwordx4 v2, s[8:11], s34 offen offset:1024 lds
  buffer_load_dwordx4 v2, s[8:11], s34 offen offset:2048 lds
  buffer_load_dwordx4 v2, s[8:11], s34 offen offset:3072 lds
  s_add_u32 s35, s35, 4096
  s_add_u32 s34, s34, 4096
  s_mov_b32 m0, s35
  s_nop 0
  buffer_load_dwordx4 v2, s[8:11], s34 offen offset:0 lds
  s_mov_b32 s12, s6
  s_and_b32 s13, s7, 0xffff
  s_mov_b32 s14, 2621440
  s_mov_b32 s15, 0x20000
  s_mov_b32 s16, s38
  s_and_b32 s17, s39, 0xffff
  s_mov_b32 s18, 2621440
  s_mov_b32 s19, 0x20000
  s_lshl_b32 s26, s20, 7
  s_add_u32 s26, s26, 28606464
  s_lshl_b32 s27, s21, 7
  s_add_u32 s27, s27, 28608512
  s_mov_b32 s25, 0
  s_mov_b32 s24, 0
  v_lshrrev_b32 v9, 4, v1
  v_lshlrev_b32 v253, 6, v1
  v_and_b32 v10, 15, v1
  v_lshlrev_b32 v11, 7, v9
  v_lshl_add_u32 v11, v10, 3, v11
  v_mov_b32 v3, v2
  v_add_u32 v4, 0x10000, v2
  v_add_u32 v5, 0x20000, v2
  v_and_b32 v140, 7, v1
  v_lshlrev_b32 v140, 4, v140
  v_lshl_add_u32 v6, v9, 7, v140
  v_add_u32 v7, 0x10000, v6
  v_add_u32 v8, 0x20000, v6
  v_cmp_gt_u32 s[40:41], 8, v10
  v_and_b32 v140, 4, v10
  v_cmp_eq_u32 s[58:59], 0, v140
  v_cmp_eq_u32 s[42:43], 0, v9
  v_cmp_eq_u32 s[44:45], 1, v9
  v_cmp_eq_u32 s[46:47], 2, v9
  s_mov_b32 s48, 0x3fb8aa3b
  s_mov_b32 s49, 0x3fb8aa3b
  s_mov_b32 s50, 0x358637bd
  s_mov_b32 s51, 0x358637bd
  s_mov_b32 s52, 0
  s_mov_b32 s53, -1
  s_mov_b32 s54, -1
  s_mov_b32 s55, 0
  v_lshrrev_b32 v140, 7, v0
  s_mov_b32 s60, 163840
  v_mul_lo_u32 v140, v140, s60
  v_and_b32 v141, 127, v0
  v_lshl_add_u32 v140, v141, 2, v140
  s_lshl_b32 s60, s21, 9
  s_add_u32 s60, s60, 6553600
  s_mov_b32 s28, 0
  s_mul_i32 s60, s28, 2621440
  s_lshl_b32 s61, s20, 3
  s_lshl_b32 s62, s3, 1
  s_add_u32 s61, s61, s62
  s_mul_i32 s61, s61, 20480
  s_add_u32 s60, s60, s61
  s_add_u32 s36, s60, 6881280
  s_add_u32 s37, s36, 20480
  s_mul_i32 s60, s28, 131072
  s_lshl_b32 s61, s20, 13
  s_add_u32 s60, s60, s61
  s_lshl_b32 s61, s3, 11
  s_add_u32 s60, s60, s61
  s_add_u32 s65, s60, 27852800
  buffer_load_dwordx4 a[0:3], v2, s[8:11], s36 offen offset:0 sc1
  buffer_load_dwordx4 a[4:7], v2, s[8:11], s37 offen offset:0 sc1
  buffer_load_dwordx2 v[208:209], v11, s[8:11], s65 offen offset:0 sc1
  buffer_load_dwordx2 v[210:211], v11, s[8:11], s65 offen offset:512 sc1
  buffer_load_dwordx2 v[212:213], v11, s[8:11], s65 offen offset:1024 sc1
  buffer_load_dwordx2 v[214:215], v11, s[8:11], s65 offen offset:1536 sc1
  buffer_load_dwordx4 a[8:11], v2, s[8:11], s36 offen offset:1024 sc1
  buffer_load_dwordx4 a[12:15], v2, s[8:11], s37 offen offset:1024 sc1
  buffer_load_dwordx4 a[16:19], v2, s[8:11], s36 offen offset:2048 sc1
  buffer_load_dwordx4 a[20:23], v2, s[8:11], s37 offen offset:2048 sc1
  buffer_load_dwordx4 a[24:27], v2, s[8:11], s36 offen offset:3072 sc1
  buffer_load_dwordx4 a[28:31], v2, s[8:11], s37 offen offset:3072 sc1
  s_add_u32 s36, s36, 4096
  s_add_u32 s37, s37, 4096
  buffer_load_dwordx4 a[32:35], v2, s[8:11], s36 offen offset:0 sc1
  buffer_load_dwordx4 a[36:39], v2, s[8:11], s37 offen offset:0 sc1
  v_mov_b32 v248, v140
  s_lshl_b32 s60, s20, 3
  s_lshl_b32 s61, s23, 2
  s_add_u32 s60, s60, s61
  s_add_u32 s67, s60, s3
  s_lshl_b32 s60, s20, 3
  s_lshl_b32 s61, s3, 1
  s_add_u32 s60, s60, s61
  s_mul_i32 s61, s60, 20480
  s_lshl_b32 s62, s21, 10
  s_add_u32 s76, s61, s62
  s_add_u32 s76, s76, 17367040
  s_lshr_b32 s62, s21, 2
  s_add_u32 s62, s62, 16
  s_lshl_b32 s62, s62, 10
  s_and_b32 s63, s21, 3
  s_lshl_b32 s63, s63, 8
  s_add_u32 s62, s62, s63
  s_add_u32 s77, s61, s62
  s_add_u32 s77, s77, 17367040
  s_lshl_b32 s60, s60, 10
  s_lshl_b32 s62, s21, 6
  s_add_u32 s84, s60, s62
  s_add_u32 s84, s84, 43302912
  s_mul_i32 s61, s67, 20480
  s_add_u32 s83, s61, 17367040
  s_lshl_b32 s62, s22, 11
  s_add_u32 s80, s61, s62
  s_add_u32 s80, s80, 9502720
  s_lshr_b32 s62, s22, 1
  s_add_u32 s62, s62, 16
  s_lshl_b32 s62, s62, 10
  s_and_b32 s63, s22, 1
  s_lshl_b32 s63, s63, 9
  s_add_u32 s62, s62, s63
  s_add_u32 s81, s61, s62
  s_add_u32 s81, s81, 9502720
  s_lshl_b32 s61, s67, 10
  s_lshl_b32 s62, s22, 7
  s_add_u32 s82, s61, s62
  s_add_u32 s82, s82, 27983872
  s_add_u32 s85, s61, 43302912
  v_mul_u32_u24 v142, 1280, v10
  v_lshl_add_u32 v249, v9, 4, v142
  v_lshl_add_u32 v250, v9, 3, v142
  s_lshl_b32 s60, s21, 9
  s_add_u32 s60, s60, 6553600
  buffer_load_dword v218, v248, s[8:11], s60 offen
  s_add_u32 s60, s60, 8192
  buffer_load_dword v219, v248, s[8:11], s60 offen
  s_add_u32 s60, s60, 8192
  buffer_load_dword v220, v248, s[8:11], s60 offen
  s_add_u32 s60, s60, 8192
  buffer_load_dword v221, v248, s[8:11], s60 offen
  s_add_u32 s60, s60, 8192
  buffer_load_dword v222, v248, s[8:11], s60 offen
  s_add_u32 s60, s60, 8192
  buffer_load_dword v223, v248, s[8:11], s60 offen
  s_add_u32 s60, s60, 8192
  buffer_load_dword v224, v248, s[8:11], s60 offen
  s_add_u32 s60, s60, 8192
  buffer_load_dword v225, v248, s[8:11], s60 offen
  s_add_u32 s60, s60, 8192
  buffer_load_dword v226, v248, s[8:11], s60 offen
  s_add_u32 s60, s60, 8192
  buffer_load_dword v227, v248, s[8:11], s60 offen
  s_add_u32 s60, s60, 8192
  buffer_load_dword v228, v248, s[8:11], s60 offen
  s_add_u32 s60, s60, 8192
  buffer_load_dword v229, v248, s[8:11], s60 offen
  s_add_u32 s60, s60, 8192
  buffer_load_dword v230, v248, s[8:11], s60 offen
  s_add_u32 s60, s60, 8192
  buffer_load_dword v231, v248, s[8:11], s60 offen
  s_add_u32 s60, s60, 8192
  buffer_load_dword v232, v248, s[8:11], s60 offen
  s_add_u32 s60, s60, 8192
  buffer_load_dword v233, v248, s[8:11], s60 offen
  s_add_u32 s60, s60, 8192
  buffer_load_dword v234, v248, s[8:11], s60 offen
  s_add_u32 s60, s60, 8192
  buffer_load_dword v235, v248, s[8:11], s60 offen
  s_add_u32 s60, s60, 8192
  buffer_load_dword v236, v248, s[8:11], s60 offen
  s_add_u32 s60, s60, 8192
  buffer_load_dword v237, v248, s[8:11], s60 offen
  s_add_u32 s60, s60, 8192
  s_mul_i32 s35, s3, 13
  s_min_u32 s35, s35, 37
  s_lshl_b32 s35, s35, 10
  s_add_u32 s34, s30, s35
  s_add_u32 s34, s34, 51200
  s_mov_b32 m0, s35
  s_nop 0
  buffer_load_dwordx4 v2, s[8:11], s34 offen offset:0 lds
  buffer_load_dwordx4 v2, s[8:11], s34 offen offset:1024 lds
  buffer_load_dwordx4 v2, s[8:11], s34 offen offset:2048 lds
  buffer_load_dwordx4 v2, s[8:11], s34 offen offset:3072 lds
  s_add_u32 s35, s35, 4096
  s_add_u32 s34, s34, 4096
  s_mov_b32 m0, s35
  s_nop 0
  buffer_load_dwordx4 v2, s[8:11], s34 offen offset:0 lds
  buffer_load_dwordx4 v2, s[8:11], s34 offen offset:1024 lds
  buffer_load_dwordx4 v2, s[8:11], s34 offen offset:2048 lds
  buffer_load_dwordx4 v2, s[8:11], s34 offen offset:3072 lds
  s_add_u32 s35, s35, 4096
  s_add_u32 s34, s34, 4096
  s_mov_b32 m0, s35
  s_nop 0
  buffer_load_dwordx4 v2, s[8:11], s34 offen offset:0 lds
  buffer_load_dwordx4 v2, s[8:11], s34 offen offset:1024 lds
  buffer_load_dwordx4 v2, s[8:11], s34 offen offset:2048 lds
  buffer_load_dwordx4 v2, s[8:11], s34 offen offset:3072 lds
  s_add_u32 s35, s35, 4096
  s_add_u32 s34, s34, 4096
  s_mov_b32 m0, s35
  s_nop 0
  buffer_load_dwordx4 v2, s[8:11], s34 offen offset:0 lds
  s_getpc_b64 s[74:75]
MAIN_pf:
  s_mov_b32 s61, MAIN_end-MAIN_pf
  s_mul_i32 s60, s3, 12288
  v_lshlrev_b32 v248, 6, v1
  v_add_u32 v248, s60, v248
  v_min_u32 v249, s61, v248
  global_load_dword v252, v249, s[74:75] offset:0
  v_add_u32 v248, 4096, v248
  v_min_u32 v249, s61, v248
  global_load_dword v252, v249, s[74:75] offset:0
  v_add_u32 v248, 4096, v248
  v_min_u32 v249, s61, v248
  global_load_dword v252, v249, s[74:75] offset:0
  s_waitcnt vmcnt(16)
  v_add_f32 v218, v218, v219
  v_add_f32 v218, v218, v220
  v_add_f32 v218, v218, v221
  v_add_f32 v218, v218, v222
  v_add_f32 v218, v218, v223
  v_add_f32 v218, v218, v224
  v_add_f32 v218, v218, v225
  v_add_f32 v218, v218, v226
  v_add_f32 v218, v218, v227
  v_add_f32 v218, v218, v228
  v_add_f32 v218, v218, v229
  v_add_f32 v218, v218, v230
  v_add_f32 v218, v218, v231
  v_add_f32 v218, v218, v232
  v_add_f32 v218, v218, v233
  v_add_f32 v218, v218, v234
  v_add_f32 v218, v218, v235
  v_add_f32 v218, v218, v236
  v_add_f32 v218, v218, v237
  v_lshlrev_b32 v219, 2, v0
  v_add_u32 v219, 155648, v219
  ds_write_b32 v219, v218
  s_waitcnt lgkmcnt(0)
MAIN_loop:
  s_lshl_b32 s28, s24, 1
  s_cmp_eq_u32 s24, 0
  s_cbranch_scc1 L_als_1
  s_mul_i32 s60, s28, 2621440
  s_lshl_b32 s61, s20, 3
  s_lshl_b32 s62, s3, 1
  s_add_u32 s61, s61, s62
  s_mul_i32 s61, s61, 20480
  s_add_u32 s60, s60, s61
  s_add_u32 s36, s60, 6881280
  s_add_u32 s37, s36, 20480
  s_mul_i32 s60, s28, 131072
  s_lshl_b32 s61, s20, 13
  s_add_u32 s60, s60, s61
  s_lshl_b32 s61, s3, 11
  s_add_u32 s60, s60, s61
  s_add_u32 s65, s60, 27852800
L_als_1:
  s_cmp_eq_u32 s24, 0
  s_cbranch_scc1 L_xw0_2
  s_mul_i32 s35, s3, 13
  s_min_u32 s35, s35, 37
  s_lshl_b32 s35, s35, 10
  s_add_u32 s34, s30, s35
  s_add_u32 s34, s34, 51200
  s_mov_b32 m0, s35
  s_nop 0
  buffer_load_dwordx4 v2, s[8:11], s34 offen offset:0 lds
  buffer_load_dwordx4 v2, s[8:11], s34 offen offset:1024 lds
  buffer_load_dwordx4 v2, s[8:11], s34 offen offset:2048 lds
  buffer_load_dwordx4 v2, s[8:11], s34 offen offset:3072 lds
  s_add_u32 s35, s35, 4096
  s_add_u32 s34, s34, 4096
  s_mov_b32 m0, s35
  s_nop 0
  buffer_load_dwordx4 v2, s[8:11], s34 offen offset:0 lds
  buffer_load_dwordx4 v2, s[8:11], s34 offen offset:1024 lds
  buffer_load_dwordx4 v2, s[8:11], s34 offen offset:2048 lds
  buffer_load_dwordx4 v2, s[8:11], s34 offen offset:3072 lds
  s_add_u32 s35, s35, 4096
  s_add_u32 s34, s34, 4096
  s_mov_b32 m0, s35
  s_nop 0
  buffer_load_dwordx4 v2, s[8:11], s34 offen offset:0 lds
  buffer_load_dwordx4 v2, s[8:11], s34 offen offset:1024 lds
  buffer_load_dwordx4 v2, s[8:11], s34 offen offset:2048 lds
  buffer_load_dwordx4 v2, s[8:11], s34 offen offset:3072 lds
  s_add_u32 s35, s35, 4096
  s_add_u32 s34, s34, 4096
  s_mov_b32 m0, s35
  s_nop 0
  buffer_load_dwordx4 v2, s[8:11], s34 offen offset:0 lds
  s_mov_b32 s62, 0
L_xw_3:
  buffer_load_dwordx2 v[208:209], v11, s[8:11], s65 offen offset:0 sc1
  buffer_load_dwordx2 v[210:211], v11, s[8:11], s65 offen offset:512 sc1
  buffer_load_dwordx2 v[212:213], v11, s[8:11], s65 offen offset:1024 sc1
  buffer_load_dwordx2 v[214:215], v11, s[8:11], s65 offen offset:1536 sc1
  s_waitcnt vmcnt(0)
  v_cmp_ne_u32 vcc, -1, v209
  v_cmp_ne_u32 s[56:57], -1, v211
  s_nop 1
  s_and_b64 vcc, vcc, s[56:57]
  v_cmp_ne_u32 s[56:57], -1, v213
  s_nop 1
  s_and_b64 vcc, vcc, s[56:57]
  v_cmp_ne_u32 s[56:57], -1, v215
  s_nop 1
  s_and_b64 vcc, vcc, s[56:57]
  s_nop 1
  s_cmp_eq_u64 vcc, -1
  s_cbranch_scc1 L_xwd_4
  s_add_u32 s62, s62, 1
  s_cmp_lt_u32 s62, 400000
  s_cbranch_scc1 L_xw_3
  v_mov_b32 v140, 0xdeaf
  v_mov_b32 v141, 0
  s_mov_b32 s62, 28619264
  buffer_store_dword v140, v141, s[8:11], s62 offen sc1
L_xwd_4:
  s_barrier
  s_branch L_xw0_2j
L_xw0_2:
  s_barrier
L_xw0_2j:
  s_cmp_eq_u32 s24, 0
  s_cbranch_scc1 L_ial_5
  buffer_load_dwordx4 a[0:3], v2, s[8:11], s36 offen offset:0 sc1
  buffer_load_dwordx4 a[4:7], v2, s[8:11], s37 offen offset:0 sc1
  buffer_load_dwordx4 a[8:11], v2, s[8:11], s36 offen offset:1024 sc1
  buffer_load_dwordx4 a[12:15], v2, s[8:11], s37 offen offset:1024 sc1
  buffer_load_dwordx4 a[16:19], v2, s[8:11], s36 offen offset:2048 sc1
  buffer_load_dwordx4 a[20:23], v2, s[8:11], s37 offen offset:2048 sc1
  buffer_load_dwordx4 a[24:27], v2, s[8:11], s36 offen offset:3072 sc1
  buffer_load_dwordx4 a[28:31], v2, s[8:11], s37 offen offset:3072 sc1
  s_add_u32 s36, s36, 4096
  s_add_u32 s37, s37, 4096
  buffer_load_dwordx4 a[32:35], v2, s[8:11], s36 offen offset:0 sc1
  buffer_load_dwordx4 a[36:39], v2, s[8:11], s37 offen offset:0 sc1
L_ial_5:
  ds_read_b128 v[96:99], v3 offset:51200
  ds_read_b128 v[100:103], v3 offset:52224
  ds_read_b128 v[104:107], v3 offset:53248
  ds_read_b128 v[108:111], v3 offset:54272
  ds_read_b128 v[112:115], v3 offset:55296
  s_waitcnt vmcnt(8)
  s_waitcnt lgkmcnt(4)
  v_mfma_f32_16x16x32_bf16 v[32:35], a[0:3], v[96:99], 0
  ds_read_b128 v[116:119], v3 offset:56320
  v_mfma_f32_16x16x32_bf16 v[36:39], a[4:7], v[96:99], 0
  s_waitcnt lgkmcnt(4)
  v_mfma_f32_16x16x32_bf16 v[40:43], a[0:3], v[100:103], 0
  ds_read_b128 v[96:99], v3 offset:57344
  v_mfma_f32_16x16x32_bf16 v[44:47], a[4:7], v[100:103], 0
  s_waitcnt lgkmcnt(4)
  v_mfma_f32_16x16x32_bf16 v[48:51], a[0:3], v[104:107], 0
  ds_read_b128 v[100:103], v3 offset:58368
  buffer_load_dwordx4 a[40:43], v2, s[8:11], s36 offen offset:1024 sc1
  v_mfma_f32_16x16x32_bf16 v[52:55], a[4:7], v[104:107], 0
  s_waitcnt lgkmcnt(4)
  v_mfma_f32_16x16x32_bf16 v[56:59], a[0:3], v[108:111], 0
  ds_read_b128 v[104:107], v3 offset:59392
  v_mfma_f32_16x16x32_bf16 v[60:63], a[4:7], v[108:111], 0
  s_waitcnt lgkmcnt(4)
  v_mfma_f32_16x16x32_bf16 v[64:67], a[0:3], v[112:115], 0
  ds_read_b128 v[108:111], v3 offset:60416
  buffer_load_dwordx4 a[44:47], v2, s[8:11], s37 offen offset:1024 sc1
  v_mfma_f32_16x16x32_bf16 v[68:71], a[4:7], v[112:115], 0
  s_waitcnt vmcnt(8)
  s_waitcnt lgkmcnt(4)
  v_mfma_f32_16x16x32_bf16 v[32:35], a[8:11], v[116:119], v[32:35]
  ds_read_b128 v[112:115], v3 offset:61440
  v_mfma_f32_16x16x32_bf16 v[36:39], a[12:15], v[116:119], v[36:39]
  s_waitcnt lgkmcnt(4)
  v_mfma_f32_16x16x32_bf16 v[40:43], a[8:11], v[96:99], v[40:43]
  ds_read_b128 v[116:119], v3 offset:62464
  buffer_load_dwordx4 a[48:51], v2, s[8:11], s36 offen offset:2048 sc1
  v_mfma_f32_16x16x32_bf16 v[44:47], a[12:15], v[96:99], v[44:47]
  s_waitcnt lgkmcnt(4)
  v_mfma_f32_16x16x32_bf16 v[48:51], a[8:11], v[100:103], v[48:51]
  ds_read_b128 v[96:99], v3 offset:63488
  v_mfma_f32_16x16x32_bf16 v[52:55], a[12:15], v[100:103], v[52:55]
  s_waitcnt lgkmcnt(4)
  v_mfma_f32_16x16x32_bf16 v[56:59], a[8:11], v[104:107], v[56:59]
  ds_read_b128 v[100:103], v3 offset:64512
  buffer_load_dwordx4 a[52:55], v2, s[8:11], s37 offen offset:2048 sc1
  v_mfma_f32_16x16x32_bf16 v[60:63], a[12:15], v[104:107], v[60:63]
  s_waitcnt lgkmcnt(4)
  v_mfma_f32_16x16x32_bf16 v[64:67], a[8:11], v[108:111], v[64:67]
  ds_read_b128 v[104:107], v4 offset:0
  v_mfma_f32_16x16x32_bf16 v[68:71], a[12:15], v[108:111], v[68:71]
  s_waitcnt vmcnt(8)
  s_waitcnt lgkmcnt(4)
  v_mfma_f32_16x16x32_bf16 v[32:35], a[16:19], v[112:115], v[32:35]
  ds_read_b128 v[108:111], v4 offset:1024
  buffer_load_dwordx4 a[56:59], v2, s[8:11], s36 offen offset:3072 sc1
  v_mfma_f32_16x16x32_bf16 v[36:39], a[20:23], v[112:115], v[36:39]
  s_waitcnt lgkmcnt(4)
  v_mfma_f32_16x16x32_bf16 v[40:43], a[16:19], v[116:119], v[40:43]
  ds_read_b128 v[112:115], v4 offset:2048
  v_mfma_f32_16x16x32_bf16 v[44:47], a[20:23], v[116:119], v[44:47]
  s_waitcnt lgkmcnt(4)
  v_mfma_f32_16x16x32_bf16 v[48:51], a[16:19], v[96:99], v[48:51]
  ds_read_b128 v[116:119], v4 offset:3072
  v_mfma_f32_16x16x32_bf16 v[52:55], a[20:23], v[96:99], v[52:55]
  s_waitcnt lgkmcnt(4)
  v_mfma_f32_16x16x32_bf16 v[56:59], a[16:19], v[100:103], v[56:59]
  ds_read_b128 v[96:99], v4 offset:4096
  buffer_load_dwordx4 a[60:63], v2, s[8:11], s37 offen offset:3072 sc1
  v_mfma_f32_16x16x32_bf16 v[60:63], a[20:23], v[100:103], v[60:63]
  s_waitcnt lgkmcnt(4)
  v_mfma_f32_16x16x32_bf16 v[64:67], a[16:19], v[104:107], v[64:67]
  ds_read_b128 v[100:103], v4 offset:5120
  v_mfma_f32_16x16x32_bf16 v[68:71], a[20:23], v[104:107], v[68:71]
  s_waitcnt vmcnt(8)
  s_waitcnt lgkmcnt(4)
  v_mfma_f32_16x16x32_bf16 v[32:35], a[24:27], v[108:111], v[32:35]
  ds_read_b128 v[104:107], v4 offset:6144
  s_add_u32 s36, s36, 4096
  v_mfma_f32_16x16x32_bf16 v[36:39], a[28:31], v[108:111], v[36:39]
  s_waitcnt lgkmcnt(4)
  s_add_u32 s37, s37, 4096
  v_mfma_f32_16x16x32_bf16 v[40:43], a[24:27], v[112:115], v[40:43]
  ds_read_b128 v[108:111], v4 offset:7168
  buffer_load_dwordx4 a[64:67], v2, s[8:11], s36 offen offset:0 sc1
  v_mfma_f32_16x16x32_bf16 v[44:47], a[28:31], v[112:115], v[44:47]
  s_waitcnt lgkmcnt(4)
  v_mfma_f32_16x16x32_bf16 v[48:51], a[24:27], v[116:119], v[48:51]
  ds_read_b128 v[112:115], v4 offset:8192
  buffer_load_dwordx4 a[68:71], v2, s[8:11], s37 offen offset:0 sc1
  v_mfma_f32_16x16x32_bf16 v[52:55], a[28:31], v[116:119], v[52:55]
  s_waitcnt lgkmcnt(4)
  v_mfma_f32_16x16x32_bf16 v[56:59], a[24:27], v[96:99], v[56:59]
  ds_read_b128 v[116:119], v4 offset:9216
  v_mfma_f32_16x16x32_bf16 v[60:63], a[28:31], v[96:99], v[60:63]
  s_waitcnt lgkmcnt(4)
  v_mfma_f32_16x16x32_bf16 v[64:67], a[24:27], v[100:103], v[64:67]
  ds_read_b128 v[96:99], v4 offset:10240
  buffer_load_dwordx4 a[72:75], v2, s[8:11], s36 offen offset:1024 sc1
  v_mfma_f32_16x16x32_bf16 v[68:71], a[28:31], v[100:103], v[68:71]
  s_waitcnt vmcnt(9)
  s_waitcnt lgkmcnt(4)
  v_mfma_f32_16x16x32_bf16 v[32:35], a[32:35], v[104:107], v[32:35]
  ds_read_b128 v[100:103], v4 offset:11264
  v_mfma_f32_16x16x32_bf16 v[36:39], a[36:39], v[104:107], v[36:39]
  s_waitcnt lgkmcnt(4)
  v_mfma_f32_16x16x32_bf16 v[40:43], a[32:35], v[108:111], v[40:43]
  ds_read_b128 v[104:107], v4 offset:12288
  buffer_load_dwordx4 a[76:79], v2, s[8:11], s37 offen offset:1024 sc1
  v_mfma_f32_16x16x32_bf16 v[44:47], a[36:39], v[108:111], v[44:47]
  s_waitcnt lgkmcnt(4)
  v_mfma_f32_16x16x32_bf16 v[48:51], a[32:35], v[112:115], v[48:51]
  ds_read_b128 v[108:111], v4 offset:13312
  v_mfma_f32_16x16x32_bf16 v[52:55], a[36:39], v[112:115], v[52:55]
  s_waitcnt lgkmcnt(4)
  v_mfma_f32_16x16x32_bf16 v[56:59], a[32:35], v[116:119], v[56:59]
  ds_read_b128 v[112:115], v4 offset:14336
  buffer_load_dwordx4 a[80:83], v2, s[8:11], s36 offen offset:2048 sc1
  v_mfma_f32_16x16x32_bf16 v[60:63], a[36:39], v[116:119], v[60:63]
  s_waitcnt lgkmcnt(4)
  v_mfma_f32_16x16x32_bf16 v[64:67], a[32:35], v[96:99], v[64:67]
  ds_read_b128 v[116:119], v4 offset:15360
  v_mfma_f32_16x16x32_bf16 v[68:71], a[36:39], v[96:99], v[68:71]
  s_waitcnt vmcnt(9)
  s_waitcnt lgkmcnt(4)
  v_mfma_f32_16x16x32_bf16 v[32:35], a[40:43], v[100:103], v[32:35]
  ds_read_b128 v[96:99], v4 offset:16384
  v_mfma_f32_16x16x32_bf16 v[36:39], a[44:47], v[100:103], v[36:39]
  s_waitcnt lgkmcnt(4)
  v_mfma_f32_16x16x32_bf16 v[40:43], a[40:43], v[104:107], v[40:43]
  ds_read_b128 v[100:103], v4 offset:17408
  buffer_load_dwordx4 a[84:87], v2, s[8:11], s37 offen offset:2048 sc1
  v_mfma_f32_16x16x32_bf16 v[44:47], a[44:47], v[104:107], v[44:47]
  s_waitcnt lgkmcnt(4)
  v_add_f32 v208, v208, v210
  v_mfma_f32_16x16x32_bf16 v[48:51], a[40:43], v[108:111], v[48:51]
  ds_read_b128 v[104:107], v4 offset:18432
  v_add_f32 v209, v209, v211
  v_mfma_f32_16x16x32_bf16 v[52:55], a[44:47], v[108:111], v[52:55]
  s_waitcnt lgkmcnt(4)
  v_mfma_f32_16x16x32_bf16 v[56:59], a[40:43], v[112:115], v[56:59]
  ds_read_b128 v[108:111], v4 offset:19456
  buffer_load_dwordx4 a[88:91], v2, s[8:11], s36 offen offset:3072 sc1
  v_mfma_f32_16x16x32_bf16 v[60:63], a[44:47], v[112:115], v[60:63]
  s_waitcnt lgkmcnt(4)
  v_add_f32 v212, v212, v214
  v_mfma_f32_16x16x32_bf16 v[64:67], a[40:43], v[116:119], v[64:67]
  ds_read_b128 v[112:115], v4 offset:20480
  v_add_f32 v213, v213, v215
  v_mfma_f32_16x16x32_bf16 v[68:71], a[44:47], v[116:119], v[68:71]
  s_waitcnt vmcnt(9)
  s_waitcnt lgkmcnt(4)
  v_mfma_f32_16x16x32_bf16 v[32:35], a[48:51], v[96:99], v[32:35]
  ds_read_b128 v[116:119], v4 offset:21504
  buffer_load_dwordx4 a[92:95], v2, s[8:11], s37 offen offset:3072 sc1
  v_mfma_f32_16x16x32_bf16 v[36:39], a[52:55], v[96:99], v[36:39]
  s_waitcnt lgkmcnt(4)
  s_lshl_b32 s64, s3, 7
  v_mfma_f32_16x16x32_bf16 v[40:43], a[48:51], v[100:103], v[40:43]
  ds_read_b128 v[96:99], v4 offset:22528
  v_and_b32 v216, 31, v1
  v_mfma_f32_16x16x32_bf16 v[44:47], a[52:55], v[100:103], v[44:47]
  s_waitcnt lgkmcnt(4)
  v_mfma_f32_16x16x32_bf16 v[48:51], a[48:51], v[104:107], v[48:51]
  ds_read_b128 v[100:103], v4 offset:23552
  s_add_u32 s36, s36, 4096
  v_mfma_f32_16x16x32_bf16 v[52:55], a[52:55], v[104:107], v[52:55]
  s_waitcnt lgkmcnt(4)
  s_add_u32 s37, s37, 4096
  v_mfma_f32_16x16x32_bf16 v[56:59], a[48:51], v[108:111], v[56:59]
  ds_read_b128 v[104:107], v4 offset:24576
  buffer_load_dwordx4 a[96:99], v2, s[8:11], s36 offen offset:0 sc1
  v_mfma_f32_16x16x32_bf16 v[60:63], a[52:55], v[108:111], v[60:63]
  s_waitcnt lgkmcnt(4)
  v_permlane32_swap_b32 v208, v209
  v_mfma_f32_16x16x32_bf16 v[64:67], a[48:51], v[112:115], v[64:67]
  ds_read_b128 v[108:111], v4 offset:25600
  buffer_load_dwordx4 a[100:103], v2, s[8:11], s37 offen offset:0 sc1
  v_mfma_f32_16x16x32_bf16 v[68:71], a[52:55], v[112:115], v[68:71]
  s_waitcnt vmcnt(10)
  s_waitcnt lgkmcnt(4)
  v_mfma_f32_16x16x32_bf16 v[32:35], a[56:59], v[116:119], v[32:35]
  ds_read_b128 v[112:115], v4 offset:26624
  v_permlane32_swap_b32 v212, v213
  v_mfma_f32_16x16x32_bf16 v[36:39], a[60:63], v[116:119], v[36:39]
  s_waitcnt lgkmcnt(4)
  v_lshl_add_u32 v216, v216, 2, s64
  v_mfma_f32_16x16x32_bf16 v[40:43], a[56:59], v[96:99], v[40:43]
  ds_read_b128 v[116:119], v4 offset:27648
  buffer_load_dwordx4 a[104:107], v2, s[8:11], s36 offen offset:1024 sc1
  v_mfma_f32_16x16x32_bf16 v[44:47], a[60:63], v[96:99], v[44:47]
  s_waitcnt lgkmcnt(4)
  v_add_u32 v216, 156672, v216
  v_mfma_f32_16x16x32_bf16 v[48:51], a[56:59], v[100:103], v[48:51]
  ds_read_b128 v[96:99], v4 offset:28672
  v_add_f32 v208, v208, v209
  v_mfma_f32_16x16x32_bf16 v[52:55], a[60:63], v[100:103], v[52:55]
  s_waitcnt lgkmcnt(4)
  v_add_f32 v212, v212, v213
  v_mfma_f32_16x16x32_bf16 v[56:59], a[56:59], v[104:107], v[56:59]
  ds_read_b128 v[100:103], v4 offset:29696
  v_permlane16_swap_b32 v208, v212
  v_mfma_f32_16x16x32_bf16 v[60:63], a[60:63], v[104:107], v[60:63]
  s_waitcnt lgkmcnt(4)
  v_mfma_f32_16x16x32_bf16 v[64:67], a[56:59], v[108:111], v[64:67]
  ds_read_b128 v[104:107], v4 offset:30720
  buffer_load_dwordx4 a[108:111], v2, s[8:11], s37 offen offset:1024 sc1
  v_mfma_f32_16x16x32_bf16 v[68:71], a[60:63], v[108:111], v[68:71]
  s_waitcnt vmcnt(10)
  s_waitcnt lgkmcnt(4)
  v_mfma_f32_16x16x32_bf16 v[32:35], a[64:67], v[112:115], v[32:35]
  ds_read_b128 v[108:111], v4 offset:31744
  v_add_f32 v208, v208, v212
  v_mfma_f32_16x16x32_bf16 v[36:39], a[68:71], v[112:115], v[36:39]
  s_waitcnt lgkmcnt(4)
  v_mov_b32 v209, v208
  v_mfma_f32_16x16x32_bf16 v[40:43], a[64:67], v[116:119], v[40:43]
  ds_read_b128 v[112:115], v4 offset:32768
  buffer_load_dwordx4 a[112:115], v2, s[8:11], s36 offen offset:2048 sc1
  v_mfma_f32_16x16x32_bf16 v[44:47], a[68:71], v[116:119], v[44:47]
  s_waitcnt lgkmcnt(4)
  v_permlane32_swap_b32 v208, v209
  v_mfma_f32_16x16x32_bf16 v[48:51], a[64:67], v[96:99], v[48:51]
  ds_read_b128 v[116:119], v4 offset:33792
  v_mul_f32 v208, 0x3acccccd, v208
  v_mfma_f32_16x16x32_bf16 v[52:55], a[68:71], v[96:99], v[52:55]
  s_waitcnt lgkmcnt(4)
  v_mfma_f32_16x16x32_bf16 v[56:59], a[64:67], v[100:103], v[56:59]
  ds_read_b128 v[96:99], v4 offset:34816
  buffer_load_dwordx4 a[116:119], v2, s[8:11], s37 offen offset:2048 sc1
  v_mfma_f32_16x16x32_bf16 v[60:63], a[68:71], v[100:103], v[60:63]
  s_waitcnt lgkmcnt(4)
  v_mul_f32 v209, 0x3acccccd, v209
  v_mfma_f32_16x16x32_bf16 v[64:67], a[64:67], v[104:107], v[64:67]
  ds_read_b128 v[100:103], v4 offset:35840
  v_fma_f32 v209, -v208, v208, v209
  v_mfma_f32_16x16x32_bf16 v[68:71], a[68:71], v[104:107], v[68:71]
  s_waitcnt vmcnt(10)
  s_waitcnt lgkmcnt(4)
  v_mfma_f32_16x16x32_bf16 v[32:35], a[72:75], v[108:111], v[32:35]
  s_cmp_lg_u32 s24, 0
  s_cbranch_scc1 L_b0_6
  s_barrier
L_b0_6:
  ds_read_b128 v[104:107], v3 offset:0
  buffer_load_dwordx4 a[120:123], v2, s[8:11], s36 offen offset:3072 sc1
  v_mfma_f32_16x16x32_bf16 v[36:39], a[76:79], v[108:111], v[36:39]
  s_waitcnt lgkmcnt(4)
  v_max_f32 v209, 0, v209
  v_mfma_f32_16x16x32_bf16 v[40:43], a[72:75], v[112:115], v[40:43]
  ds_read_b128 v[108:111], v3 offset:1024
  v_add_f32 v209, 0x3727c5ac, v209
  v_mfma_f32_16x16x32_bf16 v[44:47], a[76:79], v[112:115], v[44:47]
  s_waitcnt lgkmcnt(4)
  v_mfma_f32_16x16x32_bf16 v[48:51], a[72:75], v[116:119], v[48:51]
  ds_read_b128 v[112:115], v3 offset:2048
  buffer_load_dwordx4 a[124:127], v2, s[8:11], s37 offen offset:3072 sc1
  v_mfma_f32_16x16x32_bf16 v[52:55], a[76:79], v[116:119], v[52:55]
  s_waitcnt lgkmcnt(4)
  v_rsq_f32 v209, v209
  v_mfma_f32_16x16x32_bf16 v[56:59], a[72:75], v[96:99], v[56:59]
  ds_read_b128 v[116:119], v3 offset:3072
  v_mul_f32 v208, v208, v209
  v_mfma_f32_16x16x32_bf16 v[60:63], a[76:79], v[96:99], v[60:63]
  s_waitcnt lgkmcnt(4)
  v_mfma_f32_16x16x32_bf16 v[64:67], a[72:75], v[100:103], v[64:67]
  ds_read_b128 v[96:99], v3 offset:4096
  v_sub_f32 v208, 0, v208
  v_mfma_f32_16x16x32_bf16 v[68:71], a[76:79], v[100:103], v[68:71]
  s_waitcnt vmcnt(10)
  s_waitcnt lgkmcnt(4)
  v_mfma_f32_16x16x32_bf16 v[32:35], a[80:83], v[104:107], v[32:35]
  ds_read_b128 v[100:103], v3 offset:5120
  s_add_u32 s36, s36, 4096
  v_mfma_f32_16x16x32_bf16 v[36:39], a[84:87], v[104:107], v[36:39]
  s_waitcnt lgkmcnt(4)
  s_add_u32 s37, s37, 4096
  v_mfma_f32_16x16x32_bf16 v[40:43], a[80:83], v[108:111], v[40:43]
  ds_read_b128 v[104:107], v3 offset:6144
  buffer_load_dwordx4 a[128:131], v2, s[8:11], s36 offen offset:0 sc1
  v_mfma_f32_16x16x32_bf16 v[44:47], a[84:87], v[108:111], v[44:47]
  s_waitcnt lgkmcnt(4)
  ds_write_b32 v216, v209
  v_mfma_f32_16x16x32_bf16 v[48:51], a[80:83], v[112:115], v[48:51]
  ds_read_b128 v[108:111], v3 offset:7168
  buffer_load_dwordx4 a[132:135], v2, s[8:11], s37 offen offset:0 sc1
  v_mfma_f32_16x16x32_bf16 v[52:55], a[84:87], v[112:115], v[52:55]
  s_waitcnt lgkmcnt(5)
  ds_write_b32 v216, v208 offset:512
  v_mfma_f32_16x16x32_bf16 v[56:59], a[80:83], v[116:119], v[56:59]
  ds_read_b128 v[112:115], v3 offset:8192
  v_mfma_f32_16x16x32_bf16 v[60:63], a[84:87], v[116:119], v[60:63]
  s_waitcnt lgkmcnt(6)
  v_mfma_f32_16x16x32_bf16 v[64:67], a[80:83], v[96:99], v[64:67]
  ds_read_b128 v[116:119], v3 offset:9216
  buffer_load_dwordx4 a[136:139], v2, s[8:11], s36 offen offset:1024 sc1
  v_mfma_f32_16x16x32_bf16 v[68:71], a[84:87], v[96:99], v[68:71]
  s_waitcnt vmcnt(11)
  s_waitcnt lgkmcnt(6)
  v_mfma_f32_16x16x32_bf16 v[32:35], a[88:91], v[100:103], v[32:35]
  ds_read_b128 v[96:99], v3 offset:10240
  s_lshl_b32 s64, s3, 7
  v_mfma_f32_16x16x32_bf16 v[36:39], a[92:95], v[100:103], v[36:39]
  s_waitcnt lgkmcnt(6)
  v_mfma_f32_16x16x32_bf16 v[40:43], a[88:91], v[104:107], v[40:43]
  ds_read_b128 v[100:103], v3 offset:11264
  buffer_load_dwordx4 a[140:143], v2, s[8:11], s37 offen offset:1024 sc1
  v_mfma_f32_16x16x32_bf16 v[44:47], a[92:95], v[104:107], v[44:47]
  s_waitcnt lgkmcnt(5)
  v_lshl_add_u32 v216, v9, 4, s64
  v_mfma_f32_16x16x32_bf16 v[48:51], a[88:91], v[108:111], v[48:51]
  ds_read_b128 v[104:107], v3 offset:12288
  v_add_u32 v216, 156672, v216
  v_mfma_f32_16x16x32_bf16 v[52:55], a[92:95], v[108:111], v[52:55]
  s_waitcnt lgkmcnt(4)
  v_mfma_f32_16x16x32_bf16 v[56:59], a[88:91], v[112:115], v[56:59]
  ds_read_b128 v[108:111], v3 offset:13312
  buffer_load_dwordx4 a[144:147], v2, s[8:11], s36 offen offset:2048 sc1
  v_mfma_f32_16x16x32_bf16 v[60:63], a[92:95], v[112:115], v[60:63]
  s_waitcnt lgkmcnt(4)
  v_lshl_add_u32 v217, v10, 2, s64
  v_mfma_f32_16x16x32_bf16 v[64:67], a[88:91], v[116:119], v[64:67]
  ds_read_b128 v[112:115], v3 offset:14336
  v_add_u32 v217, 156672, v217
  v_mfma_f32_16x16x32_bf16 v[68:71], a[92:95], v[116:119], v[68:71]
  s_waitcnt vmcnt(11)
  s_waitcnt lgkmcnt(4)
  v_mfma_f32_16x16x32_bf16 v[32:35], a[96:99], v[96:99], v[32:35]
  ds_read_b128 v[116:119], v3 offset:15360
  buffer_load_dwordx4 a[148:151], v2, s[8:11], s37 offen offset:2048 sc1
  v_mfma_f32_16x16x32_bf16 v[36:39], a[100:103], v[96:99], v[36:39]
  s_waitcnt lgkmcnt(4)
  ds_read_b128 v[120:123], v216 offset:0
  v_mfma_f32_16x16x32_bf16 v[40:43], a[96:99], v[100:103], v[40:43]
  ds_read_b128 v[96:99], v3 offset:16384
  ds_read_b128 v[128:131], v216 offset:512
  v_mfma_f32_16x16x32_bf16 v[44:47], a[100:103], v[100:103], v[44:47]
  s_waitcnt lgkmcnt(6)
  v_mfma_f32_16x16x32_bf16 v[48:51], a[96:99], v[104:107], v[48:51]
  ds_read_b128 v[100:103], v3 offset:17408
  ds_read_b32 v136, v217 offset:0
  v_mfma_f32_16x16x32_bf16 v[52:55], a[100:103], v[104:107], v[52:55]
  s_waitcnt lgkmcnt(7)
  v_mfma_f32_16x16x32_bf16 v[56:59], a[96:99], v[108:111], v[56:59]
  ds_read_b128 v[104:107], v3 offset:18432
  buffer_load_dwordx4 a[152:155], v2, s[8:11], s36 offen offset:3072 sc1
  v_mfma_f32_16x16x32_bf16 v[60:63], a[100:103], v[108:111], v[60:63]
  s_waitcnt lgkmcnt(7)
  ds_read_b32 v138, v217 offset:512
  v_mfma_f32_16x16x32_bf16 v[64:67], a[96:99], v[112:115], v[64:67]
  ds_read_b128 v[108:111], v3 offset:19456
  ds_read_b128 v[124:127], v216 offset:64
  v_mfma_f32_16x16x32_bf16 v[68:71], a[100:103], v[112:115], v[68:71]
  s_waitcnt vmcnt(11)
  s_waitcnt lgkmcnt(9)
  v_mfma_f32_16x16x32_bf16 v[32:35], a[104:107], v[116:119], v[32:35]
  ds_read_b128 v[112:115], v3 offset:20480
  buffer_load_dwordx4 a[156:159], v2, s[8:11], s37 offen offset:3072 sc1
  v_mfma_f32_16x16x32_bf16 v[36:39], a[108:111], v[116:119], v[36:39]
  s_waitcnt lgkmcnt(8)
  ds_read_b128 v[132:135], v216 offset:576
  v_mfma_f32_16x16x32_bf16 v[40:43], a[104:107], v[96:99], v[40:43]
  ds_read_b128 v[116:119], v3 offset:21504
  ds_read_b32 v137, v217 offset:64
  v_mfma_f32_16x16x32_bf16 v[44:47], a[108:111], v[96:99], v[44:47]
  s_waitcnt lgkmcnt(9)
  v_mfma_f32_16x16x32_bf16 v[48:51], a[104:107], v[100:103], v[48:51]
  ds_read_b128 v[96:99], v3 offset:22528
  ds_read_b32 v139, v217 offset:576
  v_mfma_f32_16x16x32_bf16 v[52:55], a[108:111], v[100:103], v[52:55]
  s_waitcnt lgkmcnt(9)
  v_mfma_f32_16x16x32_bf16 v[56:59], a[104:107], v[104:107], v[56:59]
  ds_read_b128 v[100:103], v3 offset:23552
  v_lshlrev_b32 v198, 2, v10
  v_mfma_f32_16x16x32_bf16 v[60:63], a[108:111], v[104:107], v[60:63]
  s_waitcnt lgkmcnt(8)
  v_mfma_f32_16x16x32_bf16 v[64:67], a[104:107], v[108:111], v[64:67]
  ds_read_b128 v[104:107], v3 offset:24576
  v_add_u32 v198, 155648, v198
  v_mfma_f32_16x16x32_bf16 v[68:71], a[108:111], v[108:111], v[68:71]
  s_waitcnt vmcnt(10)
  s_waitcnt lgkmcnt(7)
  v_mfma_f32_16x16x32_bf16 v[32:35], a[112:115], v[112:115], v[32:35]
  ds_read_b128 v[108:111], v3 offset:25600
  ds_read_b32 v144, v198 offset:0
  v_mfma_f32_16x16x32_bf16 v[36:39], a[116:119], v[112:115], v[36:39]
  s_waitcnt lgkmcnt(7)
  v_mfma_f32_16x16x32_bf16 v[40:43], a[112:115], v[116:119], v[40:43]
  ds_read_b128 v[112:115], v3 offset:26624
  ds_read_b32 v145, v198 offset:64
  v_mfma_f32_16x16x32_bf16 v[44:47], a[116:119], v[116:119], v[44:47]
  s_waitcnt lgkmcnt(7)
  v_mfma_f32_16x16x32_bf16 v[48:51], a[112:115], v[96:99], v[48:51]
  ds_read_b128 v[116:119], v3 offset:27648
  ds_read_b32 v146, v198 offset:128
  v_mfma_f32_16x16x32_bf16 v[52:55], a[116:119], v[96:99], v[52:55]
  s_waitcnt lgkmcnt(7)
  v_mfma_f32_16x16x32_bf16 v[56:59], a[112:115], v[100:103], v[56:59]
  ds_read_b128 v[96:99], v3 offset:28672
  ds_read_b32 v147, v198 offset:192
  v_mfma_f32_16x16x32_bf16 v[60:63], a[116:119], v[100:103], v[60:63]
  s_waitcnt lgkmcnt(8)
  v_mfma_f32_16x16x32_bf16 v[64:67], a[112:115], v[104:107], v[64:67]
  ds_read_b128 v[100:103], v3 offset:29696
  ds_read_b32 v148, v198 offset:256
  v_mfma_f32_16x16x32_bf16 v[68:71], a[116:119], v[104:107], v[68:71]
  s_waitcnt vmcnt(8)
  s_waitcnt lgkmcnt(9)
  v_mfma_f32_16x16x32_bf16 v[32:35], a[120:123], v[108:111], v[32:35]
  ds_read_b128 v[104:107], v3 offset:30720
  s_mul_i32 s35, s3, 13
  v_mfma_f32_16x16x32_bf16 v[36:39], a[124:127], v[108:111], v[36:39]
  s_waitcnt lgkmcnt(8)
  s_min_u32 s35, s35, 37
  v_mfma_f32_16x16x32_bf16 v[40:43], a[120:123], v[112:115], v[40:43]
  ds_read_b128 v[108:111], v3 offset:31744
  s_lshl_b32 s35, s35, 10
  v_mfma_f32_16x16x32_bf16 v[44:47], a[124:127], v[112:115], v[44:47]
  s_waitcnt lgkmcnt(7)
  s_add_u32 s34, s30, s35
  v_mfma_f32_16x16x32_bf16 v[48:51], a[120:123], v[116:119], v[48:51]
  ds_read_b128 v[112:115], v3 offset:32768
  s_add_u32 s34, s34, 102400
  v_mfma_f32_16x16x32_bf16 v[52:55], a[124:127], v[116:119], v[52:55]
  s_waitcnt lgkmcnt(6)
  s_add_u32 s35, s35, 102400
  v_mfma_f32_16x16x32_bf16 v[56:59], a[120:123], v[96:99], v[56:59]
  ds_read_b128 v[116:119], v3 offset:33792
  s_mov_b32 m0, s35
  v_mfma_f32_16x16x32_bf16 v[60:63], a[124:127], v[96:99], v[60:63]
  s_waitcnt lgkmcnt(5)
  buffer_load_dwordx4 v2, s[8:11], s34 offen offset:0 lds
  v_mfma_f32_16x16x32_bf16 v[64:67], a[120:123], v[100:103], v[64:67]
  ds_read_b128 v[96:99], v3 offset:34816
  buffer_load_dwordx4 v2, s[8:11], s34 offen offset:1024 lds
  v_mfma_f32_16x16x32_bf16 v[68:71], a[124:127], v[100:103], v[68:71]
  s_waitcnt vmcnt(8)
  s_waitcnt lgkmcnt(4)
  v_mfma_f32_16x16x32_bf16 v[32:35], a[128:131], v[104:107], v[32:35]
  ds_read_b128 v[100:103], v3 offset:35840
  buffer_load_dwordx4 v2, s[8:11], s34 offen offset:2048 lds
  v_mfma_f32_16x16x32_bf16 v[36:39], a[132:135], v[104:107], v[36:39]
  s_waitcnt lgkmcnt(4)
  buffer_load_dwordx4 v2, s[8:11], s34 offen offset:3072 lds
  v_mfma_f32_16x16x32_bf16 v[40:43], a[128:131], v[108:111], v[40:43]
  ds_read_b128 v[104:107], v3 offset:36864
  s_add_u32 s35, s35, 4096
  v_mfma_f32_16x16x32_bf16 v[44:47], a[132:135], v[108:111], v[44:47]
  s_waitcnt lgkmcnt(4)
  s_add_u32 s34, s34, 4096
  v_mfma_f32_16x16x32_bf16 v[48:51], a[128:131], v[112:115], v[48:51]
  ds_read_b128 v[108:111], v3 offset:37888
  s_mov_b32 m0, s35
  v_mfma_f32_16x16x32_bf16 v[52:55], a[132:135], v[112:115], v[52:55]
  s_waitcnt lgkmcnt(4)
  buffer_load_dwordx4 v2, s[8:11], s34 offen offset:0 lds
  v_mfma_f32_16x16x32_bf16 v[56:59], a[128:131], v[116:119], v[56:59]
  ds_read_b128 v[112:115], v3 offset:38912
  buffer_load_dwordx4 v2, s[8:11], s34 offen offset:1024 lds
  v_mfma_f32_16x16x32_bf16 v[60:63], a[132:135], v[116:119], v[60:63]
  s_waitcnt lgkmcnt(4)
  buffer_load_dwordx4 v2, s[8:11], s34 offen offset:2048 lds
  v_mfma_f32_16x16x32_bf16 v[64:67], a[128:131], v[96:99], v[64:67]
  ds_read_b128 v[116:119], v3 offset:39936
  buffer_load_dwordx4 v2, s[8:11], s34 offen offset:3072 lds
  v_mfma_f32_16x16x32_bf16 v[68:71], a[132:135], v[96:99], v[68:71]
  s_waitcnt vmcnt(12)
  s_waitcnt lgkmcnt(4)
  v_mfma_f32_16x16x32_bf16 v[32:35], a[136:139], v[100:103], v[32:35]
  ds_read_b128 v[96:99], v3 offset:40960
  s_add_u32 s35, s35, 4096
  v_mfma_f32_16x16x32_bf16 v[36:39], a[140:143], v[100:103], v[36:39]
  s_waitcnt lgkmcnt(4)
  s_add_u32 s34, s34, 4096
  v_mfma_f32_16x16x32_bf16 v[40:43], a[136:139], v[104:107], v[40:43]
  ds_read_b128 v[100:103], v3 offset:41984
  s_mov_b32 m0, s35
  v_mfma_f32_16x16x32_bf16 v[44:47], a[140:143], v[104:107], v[44:47]
  s_waitcnt lgkmcnt(4)
  buffer_load_dwordx4 v2, s[8:11], s34 offen offset:0 lds
  v_mfma_f32_16x16x32_bf16 v[48:51], a[136:139], v[108:111], v[48:51]
  ds_read_b128 v[104:107], v3 offset:43008
  buffer_load_dwordx4 v2, s[8:11], s34 offen offset:1024 lds
  v_mfma_f32_16x16x32_bf16 v[52:55], a[140:143], v[108:111], v[52:55]
  s_waitcnt lgkmcnt(4)
  buffer_load_dwordx4 v2, s[8:11], s34 offen offset:2048 lds
  v_mfma_f32_16x16x32_bf16 v[56:59], a[136:139], v[112:115], v[56:59]
  ds_read_b128 v[108:111], v3 offset:44032
  buffer_load_dwordx4 v2, s[8:11], s34 offen offset:3072 lds
  v_mfma_f32_16x16x32_bf16 v[60:63], a[140:143], v[112:115], v[60:63]
  s_waitcnt lgkmcnt(4)
  s_add_u32 s35, s35, 4096
  v_mfma_f32_16x16x32_bf16 v[64:67], a[136:139], v[116:119], v[64:67]
  ds_read_b128 v[112:115], v3 offset:45056
  s_add_u32 s34, s34, 4096
  v_mfma_f32_16x16x32_bf16 v[68:71], a[140:143], v[116:119], v[68:71]
  s_waitcnt vmcnt(14)
  s_waitcnt lgkmcnt(4)
  v_mfma_f32_16x16x32_bf16 v[32:35], a[144:147], v[96:99], v[32:35]
  ds_read_b128 v[116:119], v3 offset:46080
  s_mov_b32 m0, s35
  v_mfma_f32_16x16x32_bf16 v[36:39], a[148:151], v[96:99], v[36:39]
  s_waitcnt lgkmcnt(4)
  buffer_load_dwordx4 v2, s[8:11], s34 offen offset:0 lds
  v_mfma_f32_16x16x32_bf16 v[40:43], a[144:147], v[100:103], v[40:43]
  ds_read_b128 v[96:99], v3 offset:47104
  v_mfma_f32_16x16x32_bf16 v[44:47], a[148:151], v[100:103], v[44:47]
  s_waitcnt lgkmcnt(4)
  v_mfma_f32_16x16x32_bf16 v[48:51], a[144:147], v[104:107], v[48:51]
  ds_read_b128 v[100:103], v3 offset:48128
  v_mfma_f32_16x16x32_bf16 v[52:55], a[148:151], v[104:107], v[52:55]
  s_waitcnt lgkmcnt(4)
  v_mfma_f32_16x16x32_bf16 v[56:59], a[144:147], v[108:111], v[56:59]
  ds_read_b128 v[104:107], v3 offset:49152
  v_mfma_f32_16x16x32_bf16 v[60:63], a[148:151], v[108:111], v[60:63]
  s_waitcnt lgkmcnt(4)
  v_mfma_f32_16x16x32_bf16 v[64:67], a[144:147], v[112:115], v[64:67]
  ds_read_b128 v[108:111], v3 offset:50176
  v_mfma_f32_16x16x32_bf16 v[68:71], a[148:151], v[112:115], v[68:71]
  s_waitcnt vmcnt(13)
  s_waitcnt lgkmcnt(4)
  v_mfma_f32_16x16x32_bf16 v[32:35], a[152:155], v[116:119], v[32:35]
  v_mfma_f32_16x16x32_bf16 v[36:39], a[156:159], v[116:119], v[36:39]
  s_waitcnt lgkmcnt(3)
  v_mfma_f32_16x16x32_bf16 v[40:43], a[152:155], v[96:99], v[40:43]
  v_mfma_f32_16x16x32_bf16 v[44:47], a[156:159], v[96:99], v[44:47]
  s_waitcnt lgkmcnt(2)
  v_mfma_f32_16x16x32_bf16 v[48:51], a[152:155], v[100:103], v[48:51]
  v_mfma_f32_16x16x32_bf16 v[52:55], a[156:159], v[100:103], v[52:55]
  s_waitcnt lgkmcnt(1)
  v_mfma_f32_16x16x32_bf16 v[56:59], a[152:155], v[104:107], v[56:59]
  v_mfma_f32_16x16x32_bf16 v[60:63], a[156:159], v[104:107], v[60:63]
  s_waitcnt lgkmcnt(0)
  v_mfma_f32_16x16x32_bf16 v[64:67], a[152:155], v[108:111], v[64:67]
  v_mfma_f32_16x16x32_bf16 v[68:71], a[156:159], v[108:111], v[68:71]
  v_mov_b32 v151, s50
  v_cndmask_b32_e64 v150, 0, v151, s[40:41]
  s_waitcnt lgkmcnt(0)
  v_pk_fma_f32 v[200:201], v[128:129], v[144:145], s[50:51] op_sel:[0,0,0] op_sel_hi:[1,0,1]
  v_pk_fma_f32 v[202:203], v[130:131], v[144:145], s[50:51] op_sel:[0,0,0] op_sel_hi:[1,0,1]
  v_pk_fma_f32 v[32:33], v[32:33], v[120:121], v[200:201]
  v_pk_fma_f32 v[34:35], v[34:35], v[122:123], v[202:203]
  v_pk_fma_f32 v[200:201], v[128:129], v[144:145], s[50:51] op_sel:[0,1,0] op_sel_hi:[1,1,1]
  v_pk_fma_f32 v[202:203], v[130:131], v[144:145], s[50:51] op_sel:[0,1,0] op_sel_hi:[1,1,1]
  v_pk_fma_f32 v[40:41], v[40:41], v[120:121], v[200:201]
  v_pk_fma_f32 v[42:43], v[42:43], v[122:123], v[202:203]
  v_pk_fma_f32 v[200:201], v[128:129], v[148:149], v[150:151] op_sel:[0,0,0] op_sel_hi:[1,0,0]
  v_pk_fma_f32 v[202:203], v[130:131], v[148:149], v[150:151] op_sel:[0,0,0] op_sel_hi:[1,0,0]
  v_pk_fma_f32 v[64:65], v[64:65], v[120:121], v[200:201]
  v_pk_fma_f32 v[66:67], v[66:67], v[122:123], v[202:203]
  v_pk_mul_f32 v[200:201], v[128:129], v[146:147] op_sel:[0,0] op_sel_hi:[1,0]
  v_pk_mul_f32 v[202:203], v[130:131], v[146:147] op_sel:[0,0] op_sel_hi:[1,0]
  v_pk_fma_f32 v[48:49], v[48:49], v[120:121], v[200:201]
  v_pk_fma_f32 v[50:51], v[50:51], v[122:123], v[202:203]
  v_pk_mul_f32 v[200:201], v[128:129], v[146:147] op_sel:[0,1] op_sel_hi:[1,1]
  v_pk_mul_f32 v[202:203], v[130:131], v[146:147] op_sel:[0,1] op_sel_hi:[1,1]
  v_pk_fma_f32 v[56:57], v[56:57], v[120:121], v[200:201]
  v_pk_fma_f32 v[58:59], v[58:59], v[122:123], v[202:203]
  v_pk_mul_f32 v[204:205], v[32:33], s[48:49]
  v_pk_mul_f32 v[206:207], v[34:35], s[48:49]
  v_exp_f32_e64 v204, v204 clamp
  v_exp_f32_e64 v205, v205 clamp
  v_exp_f32_e64 v206, v206 clamp
  v_exp_f32_e64 v207, v207 clamp
  v_max_f32 v32, s50, v32
  v_max_f32 v33, s50, v33
  v_max_f32 v34, s50, v34
  v_max_f32 v35, s50, v35
  v_pk_add_f32 v[32:33], v[32:33], v[204:205]
  v_pk_add_f32 v[34:35], v[34:35], v[206:207]
  v_pk_mul_f32 v[204:205], v[40:41], s[48:49]
  v_pk_mul_f32 v[206:207], v[42:43], s[48:49]
  v_exp_f32_e64 v204, v204 clamp
  v_exp_f32_e64 v205, v205 clamp
  v_exp_f32_e64 v206, v206 clamp
  v_exp_f32_e64 v207, v207 clamp
  v_max_f32 v40, s50, v40
  v_max_f32 v41, s50, v41
  v_max_f32 v42, s50, v42
  v_max_f32 v43, s50, v43
  v_pk_add_f32 v[40:41], v[40:41], v[204:205]
  v_pk_add_f32 v[42:43], v[42:43], v[206:207]
  v_pk_mul_f32 v[204:205], v[64:65], s[48:49]
  v_pk_mul_f32 v[206:207], v[66:67], s[48:49]
  v_exp_f32_e64 v204, v204 clamp
  v_exp_f32_e64 v205, v205 clamp
  v_exp_f32_e64 v206, v206 clamp
  v_exp_f32_e64 v207, v207 clamp
  v_max_f32 v152, s50, v64
  v_max_f32 v153, s50, v65
  v_max_f32 v154, s50, v66
  v_max_f32 v155, s50, v67
  v_pk_add_f32 v[152:153], v[152:153], v[204:205]
  v_pk_add_f32 v[154:155], v[154:155], v[206:207]
  v_cndmask_b32_e64 v64, v64, v152, s[40:41]
  v_cndmask_b32_e64 v65, v65, v153, s[40:41]
  v_cndmask_b32_e64 v66, v66, v154, s[40:41]
  v_cndmask_b32_e64 v67, v67, v155, s[40:41]
  v_cvt_pk_bf16_f32 v156, v32, v33
  v_cvt_pk_bf16_f32 v157, v34, v35
  v_cvt_pk_bf16_f32 v160, v40, v41
  v_cvt_pk_bf16_f32 v161, v42, v43
  v_cvt_pk_bf16_f32 v164, v48, v49
  v_cvt_pk_bf16_f32 v165, v50, v51
  v_cvt_pk_bf16_f32 v168, v56, v57
  v_cvt_pk_bf16_f32 v169, v58, v59
  v_cvt_pk_bf16_f32 v172, v64, v65
  v_cvt_pk_bf16_f32 v173, v66, v67
  v_pk_fma_f32 v[200:201], v[132:133], v[144:145], s[50:51] op_sel:[0,0,0] op_sel_hi:[1,0,1]
  v_pk_fma_f32 v[202:203], v[134:135], v[144:145], s[50:51] op_sel:[0,0,0] op_sel_hi:[1,0,1]
  v_pk_fma_f32 v[36:37], v[36:37], v[124:125], v[200:201]
  v_pk_fma_f32 v[38:39], v[38:39], v[126:127], v[202:203]
  v_pk_fma_f32 v[200:201], v[132:133], v[144:145], s[50:51] op_sel:[0,1,0] op_sel_hi:[1,1,1]
  v_pk_fma_f32 v[202:203], v[134:135], v[144:145], s[50:51] op_sel:[0,1,0] op_sel_hi:[1,1,1]
  v_pk_fma_f32 v[44:45], v[44:45], v[124:125], v[200:201]
  v_pk_fma_f32 v[46:47], v[46:47], v[126:127], v[202:203]
  v_pk_fma_f32 v[200:201], v[132:133], v[148:149], v[150:151] op_sel:[0,0,0] op_sel_hi:[1,0,0]
  v_pk_fma_f32 v[202:203], v[134:135], v[148:149], v[150:151] op_sel:[0,0,0] op_sel_hi:[1,0,0]
  v_pk_fma_f32 v[68:69], v[68:69], v[124:125], v[200:201]
  v_pk_fma_f32 v[70:71], v[70:71], v[126:127], v[202:203]
  v_pk_mul_f32 v[200:201], v[132:133], v[146:147] op_sel:[0,0] op_sel_hi:[1,0]
  v_pk_mul_f32 v[202:203], v[134:135], v[146:147] op_sel:[0,0] op_sel_hi:[1,0]
  v_pk_fma_f32 v[52:53], v[52:53], v[124:125], v[200:201]
  v_pk_fma_f32 v[54:55], v[54:55], v[126:127], v[202:203]
  v_pk_mul_f32 v[200:201], v[132:133], v[146:147] op_sel:[0,1] op_sel_hi:[1,1]
  v_pk_mul_f32 v[202:203], v[134:135], v[146:147] op_sel:[0,1] op_sel_hi:[1,1]
  v_pk_fma_f32 v[60:61], v[60:61], v[124:125], v[200:201]
  v_pk_fma_f32 v[62:63], v[62:63], v[126:127], v[202:203]
  v_pk_mul_f32 v[204:205], v[36:37], s[48:49]
  v_pk_mul_f32 v[206:207], v[38:39], s[48:49]
  v_exp_f32_e64 v204, v204 clamp
  v_exp_f32_e64 v205, v205 clamp
  v_exp_f32_e64 v206, v206 clamp
  v_exp_f32_e64 v207, v207 clamp
  v_max_f32 v36, s50, v36
  v_max_f32 v37, s50, v37
  v_max_f32 v38, s50, v38
  v_max_f32 v39, s50, v39
  v_pk_add_f32 v[36:37], v[36:37], v[204:205]
  v_pk_add_f32 v[38:39], v[38:39], v[206:207]
  v_pk_mul_f32 v[204:205], v[44:45], s[48:49]
  v_pk_mul_f32 v[206:207], v[46:47], s[48:49]
  v_exp_f32_e64 v204, v204 clamp
  v_exp_f32_e64 v205, v205 clamp
  v_exp_f32_e64 v206, v206 clamp
  v_exp_f32_e64 v207, v207 clamp
  v_max_f32 v44, s50, v44
  v_max_f32 v45, s50, v45
  v_max_f32 v46, s50, v46
  v_max_f32 v47, s50, v47
  v_pk_add_f32 v[44:45], v[44:45], v[204:205]
  v_pk_add_f32 v[46:47], v[46:47], v[206:207]
  v_pk_mul_f32 v[204:205], v[68:69], s[48:49]
  v_pk_mul_f32 v[206:207], v[70:71], s[48:49]
  v_exp_f32_e64 v204, v204 clamp
  v_exp_f32_e64 v205, v205 clamp
  v_exp_f32_e64 v206, v206 clamp
  v_exp_f32_e64 v207, v207 clamp
  v_max_f32 v152, s50, v68
  v_max_f32 v153, s50, v69
  v_max_f32 v154, s50, v70
  v_max_f32 v155, s50, v71
  v_pk_add_f32 v[152:153], v[152:153], v[204:205]
  v_pk_add_f32 v[154:155], v[154:155], v[206:207]
  v_cndmask_b32_e64 v68, v68, v152, s[40:41]
  v_cndmask_b32_e64 v69, v69, v153, s[40:41]
  v_cndmask_b32_e64 v70, v70, v154, s[40:41]
  v_cndmask_b32_e64 v71, v71, v155, s[40:41]
  v_cvt_pk_bf16_f32 v158, v36, v37
  v_cvt_pk_bf16_f32 v159, v38, v39
  v_cvt_pk_bf16_f32 v162, v44, v45
  v_cvt_pk_bf16_f32 v163, v46, v47
  v_cvt_pk_bf16_f32 v166, v52, v53
  v_cvt_pk_bf16_f32 v167, v54, v55
  v_cvt_pk_bf16_f32 v170, v60, v61
  v_cvt_pk_bf16_f32 v171, v62, v63
  v_cvt_pk_bf16_f32 v174, v68, v69
  v_cvt_pk_bf16_f32 v175, v70, v71
  v_mov_b32 v152, 0x3f803f80
  v_cndmask_b32_e64 v176, v172, v152, s[40:41]
  v_cndmask_b32_e64 v177, v173, v152, s[40:41]
  v_cndmask_b32_e64 v178, v174, v152, s[40:41]
  v_cndmask_b32_e64 v179, v175, v152, s[40:41]
  v_mfma_f32_16x16x32_bf16 v[32:35], v[156:159], v[164:167], 0
  v_mfma_f32_16x16x32_bf16 v[36:39], v[172:175], v[164:167], 0
  v_mfma_f32_16x16x32_bf16 v[40:43], v[160:163], v[168:171], 0
  v_mfma_f32_16x16x32_bf16 v[44:47], v[172:175], v[168:171], 0
  v_mfma_f32_16x16x32_bf16 v[48:51], v[156:159], v[176:179], 0
  v_mfma_f32_16x16x32_bf16 v[52:55], v[160:163], v[176:179], 0
  v_mfma_f32_16x16x32_bf16 v[56:59], v[172:175], v[176:179], 0
  s_mul_i32 s60, s3, 4096
  v_add_u32 v140, s60, v2
  s_nop 2
  v_cndmask_b32_e64 v36, v36, v44, s[44:45]
  v_cndmask_b32_e64 v37, v37, v45, s[44:45]
  v_cndmask_b32_e64 v38, v38, v46, s[44:45]
  v_cndmask_b32_e64 v39, v39, v47, s[44:45]
  v_cndmask_b32_e64 v48, v52, v48, s[58:59]
  v_cndmask_b32_e64 v49, v53, v49, s[58:59]
  v_cndmask_b32_e64 v50, v54, v50, s[58:59]
  v_cndmask_b32_e64 v51, v55, v51, s[58:59]
  v_permlane32_swap_b32 v36, v56
  v_permlane32_swap_b32 v37, v57
  v_permlane32_swap_b32 v38, v58
  v_permlane32_swap_b32 v39, v59
  s_waitcnt vmcnt(0)
  s_barrier
  ds_write_b128 v140, v[32:35] offset:0
  ds_write_b128 v140, v[40:43] offset:1024
  ds_write_b128 v140, v[36:39] offset:2048
  ds_write_b128 v140, v[48:51] offset:3072
  s_lshl_b32 s60, s3, 10
  v_add_u32 v140, s60, v2
  s_mul_i32 s61, s24, 114688
  s_mul_i32 s62, s21, 7168
  s_add_u32 s61, s61, s62
  s_add_u32 s66, s61, 28377088
  s_add_u32 s61, s66, s60
  v_lshlrev_b32 v141, 2, v1
  s_waitcnt lgkmcnt(0)
  s_barrier
  ds_read_b128 v[64:67], v140 offset:0
  ds_read_b128 v[68:71], v140 offset:4096
  ds_read_b128 v[72:75], v140 offset:8192
  ds_read_b128 v[76:79], v140 offset:12288
  s_waitcnt lgkmcnt(0)
  v_pk_add_f32 v[64:65], v[64:65], v[68:69]
  v_pk_add_f32 v[72:73], v[72:73], v[76:77]
  v_pk_add_f32 v[66:67], v[66:67], v[70:71]
  v_pk_add_f32 v[74:75], v[74:75], v[78:79]
  v_pk_add_f32 v[64:65], v[64:65], v[72:73]
  v_pk_add_f32 v[66:67], v[66:67], v[74:75]
  buffer_atomic_add_f32 v64, v141, s[8:11], s61 offen offset:0
  buffer_atomic_add_f32 v65, v141, s[8:11], s61 offen offset:256
  buffer_atomic_add_f32 v66, v141, s[8:11], s61 offen offset:512
  buffer_atomic_add_f32 v67, v141, s[8:11], s61 offen offset:768
  s_cmp_lg_u32 s24, 0
  s_cbranch_scc1 L_xr_7
  s_mul_i32 s60, s67, 20480
  s_mul_i32 s61, s22, 160
  s_add_u32 s60, s60, s61
  v_mul_u32_u24 v248, 1280, v10
  v_lshl_add_u32 v249, v9, 4, v248
  v_lshl_add_u32 v248, v9, 3, v248
  buffer_load_dwordx4 v[238:241], v249, s[12:15], s60 offen
  buffer_load_dwordx4 v[242:245], v249, s[12:15], s60 offen offset:64
  buffer_load_dwordx2 v[246:247], v248, s[12:15], s60 offen offset:128
L_xr_7:
  s_barrier
  ds_read_b128 v[96:99], v4 offset:36864
  ds_read_b128 v[100:103], v4 offset:37888
  ds_read_b128 v[104:107], v7 offset:38912
  ds_read_b128 v[108:111], v4 offset:39424
  ds_read_b128 v[112:115], v4 offset:40448
  s_waitcnt lgkmcnt(4)
  v_mfma_f32_16x16x32_bf16 v[32:35], v[96:99], a[0:3], 0
  ds_read_b128 v[116:119], v7 offset:41472
  v_mfma_f32_16x16x32_bf16 v[36:39], v[96:99], a[4:7], 0
  s_waitcnt lgkmcnt(4)
  v_mfma_f32_16x16x32_bf16 v[40:43], v[100:103], a[0:3], 0
  ds_read_b128 v[96:99], v4 offset:41984
  v_mfma_f32_16x16x32_bf16 v[44:47], v[100:103], a[4:7], 0
  s_waitcnt lgkmcnt(4)
  v_mfma_f32_16x16x32_bf16 v[48:51], v[104:107], a[0:3], 0
  ds_read_b128 v[100:103], v4 offset:43008
  s_mul_i32 s35, s3, 13
  v_mfma_f32_16x16x32_bf16 v[52:55], v[104:107], a[4:7], 0
  s_waitcnt lgkmcnt(4)
  s_min_u32 s35, s35, 37
  v_mfma_f32_16x16x32_bf16 v[32:35], v[108:111], a[8:11], v[32:35]
  ds_read_b128 v[104:107], v7 offset:44032
  s_lshl_b32 s35, s35, 10
  v_mfma_f32_16x16x32_bf16 v[36:39], v[108:111], a[12:15], v[36:39]
  s_waitcnt lgkmcnt(4)
  s_add_u32 s34, s32, s35
  v_mfma_f32_16x16x32_bf16 v[40:43], v[112:115], a[8:11], v[40:43]
  ds_read_b128 v[108:111], v4 offset:44544
  s_mov_b32 m0, s35
  v_mfma_f32_16x16x32_bf16 v[44:47], v[112:115], a[12:15], v[44:47]
  s_waitcnt lgkmcnt(4)
  buffer_load_dwordx4 v2, s[8:11], s34 offen offset:0 lds
  v_mfma_f32_16x16x32_bf16 v[48:51], v[116:119], a[8:11], v[48:51]
  ds_read_b128 v[112:115], v4 offset:45568
  buffer_load_dwordx4 v2, s[8:11], s34 offen offset:1024 lds
  v_mfma_f32_16x16x32_bf16 v[52:55], v[116:119], a[12:15], v[52:55]
  s_waitcnt lgkmcnt(4)
  v_mfma_f32_16x16x32_bf16 v[32:35], v[96:99], a[16:19], v[32:35]
  ds_read_b128 v[116:119], v7 offset:46592
  v_mfma_f32_16x16x32_bf16 v[36:39], v[96:99], a[20:23], v[36:39]
  s_waitcnt lgkmcnt(4)
  v_mfma_f32_16x16x32_bf16 v[40:43], v[100:103], a[16:19], v[40:43]
  ds_read_b128 v[96:99], v4 offset:47104
  v_mfma_f32_16x16x32_bf16 v[44:47], v[100:103], a[20:23], v[44:47]
  s_waitcnt lgkmcnt(4)
  v_mfma_f32_16x16x32_bf16 v[48:51], v[104:107], a[16:19], v[48:51]
  ds_read_b128 v[100:103], v4 offset:48128
  buffer_load_dwordx4 v2, s[8:11], s34 offen offset:2048 lds
  v_mfma_f32_16x16x32_bf16 v[52:55], v[104:107], a[20:23], v[52:55]
  s_waitcnt lgkmcnt(4)
  v_mfma_f32_16x16x32_bf16 v[32:35], v[108:111], a[24:27], v[32:35]
  ds_read_b128 v[104:107], v7 offset:49152
  v_mfma_f32_16x16x32_bf16 v[36:39], v[108:111], a[28:31], v[36:39]
  s_waitcnt lgkmcnt(4)
  v_mfma_f32_16x16x32_bf16 v[40:43], v[112:115], a[24:27], v[40:43]
  ds_read_b128 v[108:111], v4 offset:49664
  v_mfma_f32_16x16x32_bf16 v[44:47], v[112:115], a[28:31], v[44:47]
  s_waitcnt lgkmcnt(4)
  v_mfma_f32_16x16x32_bf16 v[48:51], v[116:119], a[24:27], v[48:51]
  ds_read_b128 v[112:115], v4 offset:50688
  buffer_load_dwordx4 v2, s[8:11], s34 offen offset:3072 lds
  v_mfma_f32_16x16x32_bf16 v[52:55], v[116:119], a[28:31], v[52:55]
  s_waitcnt lgkmcnt(4)
  v_mfma_f32_16x16x32_bf16 v[32:35], v[96:99], a[32:35], v[32:35]
  ds_read_b128 v[116:119], v7 offset:51712
  v_mfma_f32_16x16x32_bf16 v[36:39], v[96:99], a[36:39], v[36:39]
  s_waitcnt lgkmcnt(4)
  v_mfma_f32_16x16x32_bf16 v[40:43], v[100:103], a[32:35], v[40:43]
  ds_read_b128 v[96:99], v4 offset:52224
  v_mfma_f32_16x16x32_bf16 v[44:47], v[100:103], a[36:39], v[44:47]
  s_waitcnt lgkmcnt(4)
  v_mfma_f32_16x16x32_bf16 v[48:51], v[104:107], a[32:35], v[48:51]
  ds_read_b128 v[100:103], v4 offset:53248
  s_add_u32 s35, s35, 4096
  v_mfma_f32_16x16x32_bf16 v[52:55], v[104:107], a[36:39], v[52:55]
  s_waitcnt lgkmcnt(4)
  s_add_u32 s34, s34, 4096
  v_mfma_f32_16x16x32_bf16 v[32:35], v[108:111], a[40:43], v[32:35]
  ds_read_b128 v[104:107], v7 offset:54272
  s_mov_b32 m0, s35
  v_mfma_f32_16x16x32_bf16 v[36:39], v[108:111], a[44:47], v[36:39]
  s_waitcnt lgkmcnt(4)
  buffer_load_dwordx4 v2, s[8:11], s34 offen offset:0 lds
  v_mfma_f32_16x16x32_bf16 v[40:43], v[112:115], a[40:43], v[40:43]
  ds_read_b128 v[108:111], v4 offset:54784
  v_mfma_f32_16x16x32_bf16 v[44:47], v[112:115], a[44:47], v[44:47]
  s_waitcnt lgkmcnt(4)
  v_mfma_f32_16x16x32_bf16 v[48:51], v[116:119], a[40:43], v[48:51]
  ds_read_b128 v[112:115], v4 offset:55808
  buffer_load_dwordx4 v2, s[8:11], s34 offen offset:1024 lds
  v_mfma_f32_16x16x32_bf16 v[52:55], v[116:119], a[44:47], v[52:55]
  s_waitcnt lgkmcnt(4)
  v_mfma_f32_16x16x32_bf16 v[32:35], v[96:99], a[48:51], v[32:35]
  ds_read_b128 v[116:119], v7 offset:56832
  v_mfma_f32_16x16x32_bf16 v[36:39], v[96:99], a[52:55], v[36:39]
  s_waitcnt lgkmcnt(4)
  v_mfma_f32_16x16x32_bf16 v[40:43], v[100:103], a[48:51], v[40:43]
  ds_read_b128 v[96:99], v4 offset:57344
  v_mfma_f32_16x16x32_bf16 v[44:47], v[100:103], a[52:55], v[44:47]
  s_waitcnt lgkmcnt(4)
  v_mfma_f32_16x16x32_bf16 v[48:51], v[104:107], a[48:51], v[48:51]
  ds_read_b128 v[100:103], v4 offset:58368
  buffer_load_dwordx4 v2, s[8:11], s34 offen offset:2048 lds
  v_mfma_f32_16x16x32_bf16 v[52:55], v[104:107], a[52:55], v[52:55]
  s_waitcnt lgkmcnt(4)
  v_mfma_f32_16x16x32_bf16 v[32:35], v[108:111], a[56:59], v[32:35]
  ds_read_b128 v[104:107], v7 offset:59392
  v_mfma_f32_16x16x32_bf16 v[36:39], v[108:111], a[60:63], v[36:39]
  s_waitcnt lgkmcnt(4)
  v_mfma_f32_16x16x32_bf16 v[40:43], v[112:115], a[56:59], v[40:43]
  ds_read_b128 v[108:111], v4 offset:59904
  v_mfma_f32_16x16x32_bf16 v[44:47], v[112:115], a[60:63], v[44:47]
  s_waitcnt lgkmcnt(4)
  v_mfma_f32_16x16x32_bf16 v[48:51], v[116:119], a[56:59], v[48:51]
  ds_read_b128 v[112:115], v4 offset:60928
  buffer_load_dwordx4 v2, s[8:11], s34 offen offset:3072 lds
  v_mfma_f32_16x16x32_bf16 v[52:55], v[116:119], a[60:63], v[52:55]
  s_waitcnt lgkmcnt(4)
  v_mfma_f32_16x16x32_bf16 v[32:35], v[96:99], a[64:67], v[32:35]
  ds_read_b128 v[116:119], v7 offset:61952
  v_mfma_f32_16x16x32_bf16 v[36:39], v[96:99], a[68:71], v[36:39]
  s_waitcnt lgkmcnt(4)
  v_mfma_f32_16x16x32_bf16 v[40:43], v[100:103], a[64:67], v[40:43]
  ds_read_b128 v[96:99], v4 offset:62464
  v_mfma_f32_16x16x32_bf16 v[44:47], v[100:103], a[68:71], v[44:47]
  s_waitcnt lgkmcnt(4)
  v_mfma_f32_16x16x32_bf16 v[48:51], v[104:107], a[64:67], v[48:51]
  ds_read_b128 v[100:103], v4 offset:63488
  s_add_u32 s35, s35, 4096
  v_mfma_f32_16x16x32_bf16 v[52:55], v[104:107], a[68:71], v[52:55]
  s_waitcnt lgkmcnt(4)
  s_add_u32 s34, s34, 4096
  v_mfma_f32_16x16x32_bf16 v[32:35], v[108:111], a[72:75], v[32:35]
  ds_read_b128 v[104:107], v7 offset:64512
  s_mov_b32 m0, s35
  v_mfma_f32_16x16x32_bf16 v[36:39], v[108:111], a[76:79], v[36:39]
  s_waitcnt lgkmcnt(4)
  buffer_load_dwordx4 v2, s[8:11], s34 offen offset:0 lds
  v_mfma_f32_16x16x32_bf16 v[40:43], v[112:115], a[72:75], v[40:43]
  ds_read_b128 v[108:111], v4 offset:65024
  v_mfma_f32_16x16x32_bf16 v[44:47], v[112:115], a[76:79], v[44:47]
  s_waitcnt lgkmcnt(4)
  v_mfma_f32_16x16x32_bf16 v[48:51], v[116:119], a[72:75], v[48:51]
  ds_read_b128 v[112:115], v5 offset:512
  buffer_load_dwordx4 v2, s[8:11], s34 offen offset:1024 lds
  v_mfma_f32_16x16x32_bf16 v[52:55], v[116:119], a[76:79], v[52:55]
  s_waitcnt lgkmcnt(4)
  v_mfma_f32_16x16x32_bf16 v[32:35], v[96:99], a[80:83], v[32:35]
  ds_read_b128 v[116:119], v8 offset:1536
  v_mfma_f32_16x16x32_bf16 v[36:39], v[96:99], a[84:87], v[36:39]
  s_waitcnt lgkmcnt(4)
  v_mfma_f32_16x16x32_bf16 v[40:43], v[100:103], a[80:83], v[40:43]
  ds_read_b128 v[96:99], v5 offset:2048
  v_mfma_f32_16x16x32_bf16 v[44:47], v[100:103], a[84:87], v[44:47]
  s_waitcnt lgkmcnt(4)
  v_mfma_f32_16x16x32_bf16 v[48:51], v[104:107], a[80:83], v[48:51]
  ds_read_b128 v[100:103], v5 offset:3072
  buffer_load_dwordx4 v2, s[8:11], s34 offen offset:2048 lds
  v_mfma_f32_16x16x32_bf16 v[52:55], v[104:107], a[84:87], v[52:55]
  s_waitcnt lgkmcnt(4)
  v_mfma_f32_16x16x32_bf16 v[32:35], v[108:111], a[88:91], v[32:35]
  ds_read_b128 v[104:107], v8 offset:4096
  v_mfma_f32_16x16x32_bf16 v[36:39], v[108:111], a[92:95], v[36:39]
  s_waitcnt lgkmcnt(4)
  v_mfma_f32_16x16x32_bf16 v[40:43], v[112:115], a[88:91], v[40:43]
  ds_read_b128 v[108:111], v5 offset:4608
  v_mfma_f32_16x16x32_bf16 v[44:47], v[112:115], a[92:95], v[44:47]
  s_waitcnt lgkmcnt(4)
  v_mfma_f32_16x16x32_bf16 v[48:51], v[116:119], a[88:91], v[48:51]
  ds_read_b128 v[112:115], v5 offset:5632
  buffer_load_dwordx4 v2, s[8:11], s34 offen offset:3072 lds
  v_mfma_f32_16x16x32_bf16 v[52:55], v[116:119], a[92:95], v[52:55]
  s_waitcnt lgkmcnt(4)
  v_mfma_f32_16x16x32_bf16 v[32:35], v[96:99], a[96:99], v[32:35]
  ds_read_b128 v[116:119], v8 offset:6656
  s_waitcnt vmcnt(12)
  s_barrier
  s_cmp_lg_u32 s3, 0
  s_cbranch_scc1 L_csig_8
  v_mov_b32 v140, 1
  v_mov_b32 v141, 0
  s_mov_b64 exec, 1
  buffer_atomic_add v140, v141, s[8:11], s27 offen sc1
  s_mov_b64 exec, -1
L_csig_8:
  v_mfma_f32_16x16x32_bf16 v[36:39], v[96:99], a[100:103], v[36:39]
  s_waitcnt lgkmcnt(4)
  v_mfma_f32_16x16x32_bf16 v[40:43], v[100:103], a[96:99], v[40:43]
  ds_read_b128 v[96:99], v5 offset:7168
  v_mfma_f32_16x16x32_bf16 v[44:47], v[100:103], a[100:103], v[44:47]
  s_waitcnt lgkmcnt(4)
  v_mfma_f32_16x16x32_bf16 v[48:51], v[104:107], a[96:99], v[48:51]
  ds_read_b128 v[100:103], v5 offset:8192
  s_add_u32 s35, s35, 4096
  v_mfma_f32_16x16x32_bf16 v[52:55], v[104:107], a[100:103], v[52:55]
  s_waitcnt lgkmcnt(4)
  s_add_u32 s34, s34, 4096
  v_mfma_f32_16x16x32_bf16 v[32:35], v[108:111], a[104:107], v[32:35]
  ds_read_b128 v[104:107], v8 offset:9216
  s_mov_b32 m0, s35
  v_mfma_f32_16x16x32_bf16 v[36:39], v[108:111], a[108:111], v[36:39]
  s_waitcnt lgkmcnt(4)
  buffer_load_dwordx4 v2, s[8:11], s34 offen offset:0 lds
  v_mfma_f32_16x16x32_bf16 v[40:43], v[112:115], a[104:107], v[40:43]
  ds_read_b128 v[108:111], v5 offset:9728
  v_mfma_f32_16x16x32_bf16 v[44:47], v[112:115], a[108:111], v[44:47]
  s_waitcnt lgkmcnt(4)
  v_mfma_f32_16x16x32_bf16 v[48:51], v[116:119], a[104:107], v[48:51]
  ds_read_b128 v[112:115], v5 offset:10752
  v_mfma_f32_16x16x32_bf16 v[52:55], v[116:119], a[108:111], v[52:55]
  s_waitcnt lgkmcnt(4)
  v_mfma_f32_16x16x32_bf16 v[32:35], v[96:99], a[112:115], v[32:35]
  ds_read_b128 v[116:119], v8 offset:11776
  v_mfma_f32_16x16x32_bf16 v[36:39], v[96:99], a[116:119], v[36:39]
  s_waitcnt lgkmcnt(4)
  v_mfma_f32_16x16x32_bf16 v[40:43], v[100:103], a[112:115], v[40:43]
  ds_read_b128 v[96:99], v5 offset:12288
  v_mfma_f32_16x16x32_bf16 v[44:47], v[100:103], a[116:119], v[44:47]
  s_waitcnt lgkmcnt(4)
  v_mfma_f32_16x16x32_bf16 v[48:51], v[104:107], a[112:115], v[48:51]
  ds_read_b128 v[100:103], v5 offset:13312
  v_lshlrev_b32 v199, 4, v9
  v_mfma_f32_16x16x32_bf16 v[52:55], v[104:107], a[116:119], v[52:55]
  s_waitcnt lgkmcnt(4)
  v_mfma_f32_16x16x32_bf16 v[32:35], v[108:111], a[120:123], v[32:35]
  ds_read_b128 v[104:107], v8 offset:14336
  v_add_u32 v199, 155648, v199
  v_mfma_f32_16x16x32_bf16 v[36:39], v[108:111], a[124:127], v[36:39]
  s_waitcnt lgkmcnt(4)
  v_mfma_f32_16x16x32_bf16 v[40:43], v[112:115], a[120:123], v[40:43]
  ds_read_b128 v[108:111], v5 offset:14848
  ds_read_b128 v[144:147], v199 offset:320
  v_mfma_f32_16x16x32_bf16 v[44:47], v[112:115], a[124:127], v[44:47]
  s_waitcnt lgkmcnt(5)
  v_mfma_f32_16x16x32_bf16 v[48:51], v[116:119], a[120:123], v[48:51]
  ds_read_b128 v[112:115], v5 offset:15872
  ds_read_b128 v[148:151], v199 offset:384
  v_mfma_f32_16x16x32_bf16 v[52:55], v[116:119], a[124:127], v[52:55]
  s_waitcnt lgkmcnt(6)
  v_mfma_f32_16x16x32_bf16 v[32:35], v[96:99], a[128:131], v[32:35]
  ds_read_b128 v[116:119], v8 offset:16896
  ds_read_b128 v[152:155], v199 offset:448
  v_mfma_f32_16x16x32_bf16 v[36:39], v[96:99], a[132:135], v[36:39]
  s_waitcnt lgkmcnt(7)
  v_mfma_f32_16x16x32_bf16 v[40:43], v[100:103], a[128:131], v[40:43]
  ds_read_b128 v[96:99], v5 offset:17408
  v_mfma_f32_16x16x32_bf16 v[44:47], v[100:103], a[132:135], v[44:47]
  s_waitcnt lgkmcnt(7)
  v_mfma_f32_16x16x32_bf16 v[48:51], v[104:107], a[128:131], v[48:51]
  ds_read_b128 v[100:103], v5 offset:18432
  v_mfma_f32_16x16x32_bf16 v[52:55], v[104:107], a[132:135], v[52:55]
  s_waitcnt lgkmcnt(7)
  v_mfma_f32_16x16x32_bf16 v[32:35], v[108:111], a[136:139], v[32:35]
  ds_read_b128 v[104:107], v8 offset:19456
  v_mfma_f32_16x16x32_bf16 v[36:39], v[108:111], a[140:143], v[36:39]
  s_waitcnt lgkmcnt(6)
  v_mfma_f32_16x16x32_bf16 v[40:43], v[112:115], a[136:139], v[40:43]
  ds_read_b128 v[108:111], v5 offset:19968
  v_mfma_f32_16x16x32_bf16 v[44:47], v[112:115], a[140:143], v[44:47]
  s_waitcnt lgkmcnt(5)
  v_mfma_f32_16x16x32_bf16 v[48:51], v[116:119], a[136:139], v[48:51]
  ds_read_b128 v[112:115], v5 offset:20992
  v_mfma_f32_16x16x32_bf16 v[52:55], v[116:119], a[140:143], v[52:55]
  s_waitcnt lgkmcnt(4)
  v_mfma_f32_16x16x32_bf16 v[32:35], v[96:99], a[144:147], v[32:35]
  ds_read_b128 v[116:119], v8 offset:22016
  v_mfma_f32_16x16x32_bf16 v[36:39], v[96:99], a[148:151], v[36:39]
  s_waitcnt lgkmcnt(4)
  v_mfma_f32_16x16x32_bf16 v[40:43], v[100:103], a[144:147], v[40:43]
  v_mfma_f32_16x16x32_bf16 v[44:47], v[100:103], a[148:151], v[44:47]
  s_waitcnt lgkmcnt(3)
  v_mfma_f32_16x16x32_bf16 v[48:51], v[104:107], a[144:147], v[48:51]
  v_mfma_f32_16x16x32_bf16 v[52:55], v[104:107], a[148:151], v[52:55]
  s_waitcnt lgkmcnt(2)
  v_mfma_f32_16x16x32_bf16 v[32:35], v[108:111], a[152:155], v[32:35]
  v_mfma_f32_16x16x32_bf16 v[36:39], v[108:111], a[156:159], v[36:39]
  s_waitcnt lgkmcnt(1)
  v_mfma_f32_16x16x32_bf16 v[40:43], v[112:115], a[152:155], v[40:43]
  v_mfma_f32_16x16x32_bf16 v[44:47], v[112:115], a[156:159], v[44:47]
  s_waitcnt lgkmcnt(0)
  v_mfma_f32_16x16x32_bf16 v[48:51], v[116:119], a[152:155], v[48:51]
  v_mfma_f32_16x16x32_bf16 v[52:55], v[116:119], a[156:159], v[52:55]
  s_waitcnt lgkmcnt(0)
  s_barrier
  s_cmp_eq_u32 s3, 0
  s_cbranch_scc1 L_g_9
  s_sub_u32 s35, s3, 1
  s_mul_i32 s35, s35, 17
  s_min_u32 s35, s35, 33
  s_lshl_b32 s35, s35, 10
  s_add_u32 s34, s32, s35
  s_add_u32 s34, s34, 51200
  s_add_u32 s35, s35, 102400
  s_mov_b32 m0, s35
  s_nop 0
  buffer_load_dwordx4 v2, s[8:11], s34 offen offset:0 lds
  buffer_load_dwordx4 v2, s[8:11], s34 offen offset:1024 lds
  buffer_load_dwordx4 v2, s[8:11], s34 offen offset:2048 lds
L_g_9:
  v_pk_fma_f32 v[200:201], v[144:145], v[138:139], s[50:51] op_sel:[0,0,0] op_sel_hi:[1,0,1]
  v_pk_fma_f32 v[202:203], v[146:147], v[138:139], s[50:51] op_sel:[0,0,0] op_sel_hi:[1,0,1]
  v_pk_fma_f32 v[32:33], v[32:33], v[136:137], v[200:201] op_sel:[0,0,0] op_sel_hi:[1,0,1]
  v_pk_fma_f32 v[34:35], v[34:35], v[136:137], v[202:203] op_sel:[0,0,0] op_sel_hi:[1,0,1]
  v_pk_mul_f32 v[204:205], v[32:33], s[48:49]
  v_pk_mul_f32 v[206:207], v[34:35], s[48:49]
  v_exp_f32_e64 v204, v204 clamp
  v_exp_f32_e64 v205, v205 clamp
  v_exp_f32_e64 v206, v206 clamp
  v_exp_f32_e64 v207, v207 clamp
  v_max_f32 v32, s50, v32
  v_max_f32 v33, s50, v33
  v_max_f32 v34, s50, v34
  v_max_f32 v35, s50, v35
  v_pk_add_f32 v[32:33], v[32:33], v[204:205]
  v_pk_add_f32 v[34:35], v[34:35], v[206:207]
  v_cvt_pk_bf16_f32 v156, v32, v33
  v_cvt_pk_bf16_f32 v157, v34, v35
  s_cmp_eq_u32 s3, 0
  s_cbranch_scc1 L_g_10
  buffer_load_dwordx4 v2, s[8:11], s34 offen offset:3072 lds
  s_add_u32 s35, s35, 4096
  s_add_u32 s34, s34, 4096
  s_mov_b32 m0, s35
  s_nop 0
  buffer_load_dwordx4 v2, s[8:11], s34 offen offset:0 lds
  buffer_load_dwordx4 v2, s[8:11], s34 offen offset:1024 lds
L_g_10:
  v_pk_fma_f32 v[200:201], v[148:149], v[138:139], s[50:51] op_sel:[0,0,0] op_sel_hi:[1,0,1]
  v_pk_fma_f32 v[202:203], v[150:151], v[138:139], s[50:51] op_sel:[0,0,0] op_sel_hi:[1,0,1]
  v_pk_fma_f32 v[40:41], v[40:41], v[136:137], v[200:201] op_sel:[0,0,0] op_sel_hi:[1,0,1]
  v_pk_fma_f32 v[42:43], v[42:43], v[136:137], v[202:203] op_sel:[0,0,0] op_sel_hi:[1,0,1]
  v_pk_mul_f32 v[204:205], v[40:41], s[48:49]
  v_pk_mul_f32 v[206:207], v[42:43], s[48:49]
  v_exp_f32_e64 v204, v204 clamp
  v_exp_f32_e64 v205, v205 clamp
  v_exp_f32_e64 v206, v206 clamp
  v_exp_f32_e64 v207, v207 clamp
  v_max_f32 v40, s50, v40
  v_max_f32 v41, s50, v41
  v_max_f32 v42, s50, v42
  v_max_f32 v43, s50, v43
  v_pk_add_f32 v[40:41], v[40:41], v[204:205]
  v_pk_add_f32 v[42:43], v[42:43], v[206:207]
  v_cvt_pk_bf16_f32 v160, v40, v41
  v_cvt_pk_bf16_f32 v161, v42, v43
  s_cmp_eq_u32 s3, 0
  s_cbranch_scc1 L_g_11
  buffer_load_dwordx4 v2, s[8:11], s34 offen offset:2048 lds
  buffer_load_dwordx4 v2, s[8:11], s34 offen offset:3072 lds
  s_add_u32 s35, s35, 4096
  s_add_u32 s34, s34, 4096
  s_mov_b32 m0, s35
  s_nop 0
  buffer_load_dwordx4 v2, s[8:11], s34 offen offset:0 lds
L_g_11:
  v_pk_fma_f32 v[200:201], v[152:153], v[138:139], s[50:51] op_sel:[0,0,0] op_sel_hi:[1,0,1]
  v_pk_fma_f32 v[202:203], v[154:155], v[138:139], s[50:51] op_sel:[0,0,0] op_sel_hi:[1,0,1]
  v_pk_fma_f32 v[48:49], v[48:49], v[136:137], v[200:201] op_sel:[0,0,0] op_sel_hi:[1,0,1]
  v_pk_fma_f32 v[50:51], v[50:51], v[136:137], v[202:203] op_sel:[0,0,0] op_sel_hi:[1,0,1]
  v_pk_mul_f32 v[204:205], v[48:49], s[48:49]
  v_pk_mul_f32 v[206:207], v[50:51], s[48:49]
  v_exp_f32_e64 v204, v204 clamp
  v_exp_f32_e64 v205, v205 clamp
  v_exp_f32_e64 v206, v206 clamp
  v_exp_f32_e64 v207, v207 clamp
  v_max_f32 v48, s50, v48
  v_max_f32 v49, s50, v49
  v_max_f32 v50, s50, v50
  v_max_f32 v51, s50, v51
  v_pk_add_f32 v[48:49], v[48:49], v[204:205]
  v_pk_add_f32 v[50:51], v[50:51], v[206:207]
  v_cvt_pk_bf16_f32 v164, v48, v49
  v_cvt_pk_bf16_f32 v165, v50, v51
  s_cmp_eq_u32 s3, 0
  s_cbranch_scc1 L_g_12
  buffer_load_dwordx4 v2, s[8:11], s34 offen offset:1024 lds
  buffer_load_dwordx4 v2, s[8:11], s34 offen offset:2048 lds
  buffer_load_dwordx4 v2, s[8:11], s34 offen offset:3072 lds
L_g_12:
  v_pk_fma_f32 v[200:201], v[144:145], v[138:139], s[50:51] op_sel:[0,1,0] op_sel_hi:[1,1,1]
  v_pk_fma_f32 v[202:203], v[146:147], v[138:139], s[50:51] op_sel:[0,1,0] op_sel_hi:[1,1,1]
  v_pk_fma_f32 v[36:37], v[36:37], v[136:137], v[200:201] op_sel:[0,1,0] op_sel_hi:[1,1,1]
  v_pk_fma_f32 v[38:39], v[38:39], v[136:137], v[202:203] op_sel:[0,1,0] op_sel_hi:[1,1,1]
  v_pk_mul_f32 v[204:205], v[36:37], s[48:49]
  v_pk_mul_f32 v[206:207], v[38:39], s[48:49]
  v_exp_f32_e64 v204, v204 clamp
  v_exp_f32_e64 v205, v205 clamp
  v_exp_f32_e64 v206, v206 clamp
  v_exp_f32_e64 v207, v207 clamp
  v_max_f32 v36, s50, v36
  v_max_f32 v37, s50, v37
  v_max_f32 v38, s50, v38
  v_max_f32 v39, s50, v39
  v_pk_add_f32 v[36:37], v[36:37], v[204:205]
  v_pk_add_f32 v[38:39], v[38:39], v[206:207]
  v_cvt_pk_bf16_f32 v158, v36, v37
  v_cvt_pk_bf16_f32 v159, v38, v39
  s_cmp_eq_u32 s3, 0
  s_cbranch_scc1 L_g_13
  s_add_u32 s35, s35, 4096
  s_add_u32 s34, s34, 4096
  s_mov_b32 m0, s35
  s_nop 0
  buffer_load_dwordx4 v2, s[8:11], s34 offen offset:0 lds
  buffer_load_dwordx4 v2, s[8:11], s34 offen offset:1024 lds
  buffer_load_dwordx4 v2, s[8:11], s34 offen offset:2048 lds
L_g_13:
  v_pk_fma_f32 v[200:201], v[148:149], v[138:139], s[50:51] op_sel:[0,1,0] op_sel_hi:[1,1,1]
  v_pk_fma_f32 v[202:203], v[150:151], v[138:139], s[50:51] op_sel:[0,1,0] op_sel_hi:[1,1,1]
  v_pk_fma_f32 v[44:45], v[44:45], v[136:137], v[200:201] op_sel:[0,1,0] op_sel_hi:[1,1,1]
  v_pk_fma_f32 v[46:47], v[46:47], v[136:137], v[202:203] op_sel:[0,1,0] op_sel_hi:[1,1,1]
  v_pk_mul_f32 v[204:205], v[44:45], s[48:49]
  v_pk_mul_f32 v[206:207], v[46:47], s[48:49]
  v_exp_f32_e64 v204, v204 clamp
  v_exp_f32_e64 v205, v205 clamp
  v_exp_f32_e64 v206, v206 clamp
  v_exp_f32_e64 v207, v207 clamp
  v_max_f32 v44, s50, v44
  v_max_f32 v45, s50, v45
  v_max_f32 v46, s50, v46
  v_max_f32 v47, s50, v47
  v_pk_add_f32 v[44:45], v[44:45], v[204:205]
  v_pk_add_f32 v[46:47], v[46:47], v[206:207]
  v_cvt_pk_bf16_f32 v162, v44, v45
  v_cvt_pk_bf16_f32 v163, v46, v47
  s_cmp_eq_u32 s3, 0
  s_cbranch_scc1 L_g_14
  buffer_load_dwordx4 v2, s[8:11], s34 offen offset:3072 lds
  s_add_u32 s35, s35, 4096
  s_add_u32 s34, s34, 4096
  s_mov_b32 m0, s35
  s_nop 0
  buffer_load_dwordx4 v2, s[8:11], s34 offen offset:0 lds
L_g_14:
  v_pk_fma_f32 v[200:201], v[152:153], v[138:139], s[50:51] op_sel:[0,1,0] op_sel_hi:[1,1,1]
  v_pk_fma_f32 v[202:203], v[154:155], v[138:139], s[50:51] op_sel:[0,1,0] op_sel_hi:[1,1,1]
  v_pk_fma_f32 v[52:53], v[52:53], v[136:137], v[200:201] op_sel:[0,1,0] op_sel_hi:[1,1,1]
  v_pk_fma_f32 v[54:55], v[54:55], v[136:137], v[202:203] op_sel:[0,1,0] op_sel_hi:[1,1,1]
  v_pk_mul_f32 v[204:205], v[52:53], s[48:49]
  v_pk_mul_f32 v[206:207], v[54:55], s[48:49]
  v_exp_f32_e64 v204, v204 clamp
  v_exp_f32_e64 v205, v205 clamp
  v_exp_f32_e64 v206, v206 clamp
  v_exp_f32_e64 v207, v207 clamp
  v_max_f32 v52, s50, v52
  v_max_f32 v53, s50, v53
  v_max_f32 v54, s50, v54
  v_max_f32 v55, s50, v55
  v_pk_add_f32 v[52:53], v[52:53], v[204:205]
  v_pk_add_f32 v[54:55], v[54:55], v[206:207]
  v_cvt_pk_bf16_f32 v166, v52, v53
  v_cvt_pk_bf16_f32 v167, v54, v55
  v_mov_b32 v168, v156
  v_mov_b32 v169, v157
  v_cndmask_b32_e64 v170, 0, v164, s[42:43]
  v_cndmask_b32_e64 v171, 0, v165, s[42:43]
  v_mov_b32 v176, v160
  v_mov_b32 v177, v161
  v_cndmask_b32_e64 v178, 0, v164, s[44:45]
  v_cndmask_b32_e64 v179, 0, v165, s[44:45]
  v_mov_b32 v172, v158
  v_mov_b32 v173, v159
  v_cndmask_b32_e64 v174, 0, v166, s[42:43]
  v_cndmask_b32_e64 v175, 0, v167, s[42:43]
  v_mov_b32 v180, v162
  v_mov_b32 v181, v163
  v_cndmask_b32_e64 v182, 0, v166, s[44:45]
  v_cndmask_b32_e64 v183, 0, v167, s[44:45]
  s_mul_i32 s60, s28, 2621440
  s_add_u32 s70, s76, s60
  s_add_u32 s71, s77, s60
  v_and_b32 v142, 1, v9
  v_lshlrev_b32 v142, 3, v142
  v_lshl_add_u32 v142, v10, 4, v142
  s_add_u32 s64, s24, 1
  s_lshl_b32 s64, s64, 4
  s_cmp_lg_u32 s3, 0
  s_cbranch_scc1 L_wout_15
  s_cmp_eq_u32 s64, 0
  s_cbranch_scc1 L_wout_15
  v_mov_b32 v141, 0
  s_mov_b32 s62, 0
  buffer_load_dword v250, v141, s[8:11], s27 offen sc1
L_wloop_17:
  buffer_load_dword v251, v141, s[8:11], s27 offen sc1
  s_waitcnt vmcnt(1)
  v_readfirstlane_b32 s63, v250
  s_nop 1
  s_cmp_ge_u32 s63, s64
  s_cbranch_scc1 L_wfin_18
  buffer_load_dword v250, v141, s[8:11], s27 offen sc1
  s_waitcnt vmcnt(1)
  v_readfirstlane_b32 s63, v251
  s_nop 1
  s_cmp_ge_u32 s63, s64
  s_cbranch_scc1 L_wfin_18
  s_add_u32 s62, s62, 1
  s_cmp_lt_u32 s62, 400000
  s_cbranch_scc1 L_wloop_17
  s_waitcnt vmcnt(0)
  v_mov_b32 v140, 0xdead
  v_mov_b32 v141, 0
  s_mov_b32 s62, 28619264
  buffer_store_dword v140, v141, s[8:11], s62 offen sc1
L_wfin_18:
L_wout_15:
  s_barrier
  v_lshlrev_b32 v141, 2, v1
  buffer_load_dword v32, v141, s[8:11], s66 offen offset:0 sc1
  buffer_load_dword v33, v141, s[8:11], s66 offen offset:256 sc1
  buffer_load_dword v34, v141, s[8:11], s66 offen offset:512 sc1
  buffer_load_dword v35, v141, s[8:11], s66 offen offset:768 sc1
  buffer_load_dword v36, v141, s[8:11], s66 offen offset:1024 sc1
  buffer_load_dword v37, v141, s[8:11], s66 offen offset:1280 sc1
  buffer_load_dword v38, v141, s[8:11], s66 offen offset:1536 sc1
  buffer_load_dword v39, v141, s[8:11], s66 offen offset:1792 sc1
  buffer_load_dword v40, v141, s[8:11], s66 offen offset:2048 sc1
  buffer_load_dword v41, v141, s[8:11], s66 offen offset:2304 sc1
  buffer_load_dword v42, v141, s[8:11], s66 offen offset:2560 sc1
  buffer_load_dword v43, v141, s[8:11], s66 offen offset:2816 sc1
  buffer_load_dword v44, v141, s[8:11], s66 offen offset:3072 sc1
  buffer_load_dword v45, v141, s[8:11], s66 offen offset:3328 sc1
  buffer_load_dword v46, v141, s[8:11], s66 offen offset:3584 sc1
  buffer_load_dword v47, v141, s[8:11], s66 offen offset:3840 sc1
  v_mov_b32 v48, 0
  v_mov_b32 v49, 0
  v_mov_b32 v50, 0
  v_mov_b32 v51, 0
  s_waitcnt vmcnt(0)
  s_cmp_lg_u32 s24, 0
  s_cbranch_scc1 L_unp_19
  v_lshlrev_b32 v12, 16, v238
  v_and_b32 v13, 0xffff0000, v238
  v_lshlrev_b32 v14, 16, v239
  v_and_b32 v15, 0xffff0000, v239
  v_lshlrev_b32 v16, 16, v240
  v_and_b32 v17, 0xffff0000, v240
  v_lshlrev_b32 v18, 16, v241
  v_and_b32 v19, 0xffff0000, v241
  v_lshlrev_b32 v20, 16, v242
  v_and_b32 v21, 0xffff0000, v242
  v_lshlrev_b32 v22, 16, v243
  v_and_b32 v23, 0xffff0000, v243
  v_lshlrev_b32 v24, 16, v244
  v_and_b32 v25, 0xffff0000, v244
  v_lshlrev_b32 v26, 16, v245
  v_and_b32 v27, 0xffff0000, v245
  v_lshlrev_b32 v28, 16, v246
  v_and_b32 v29, 0xffff0000, v246
  v_lshlrev_b32 v30, 16, v247
  v_and_b32 v31, 0xffff0000, v247
L_unp_19:
  v_permlane32_swap_b32 v40, v48
  v_permlane32_swap_b32 v41, v49
  v_permlane32_swap_b32 v42, v50
  v_permlane32_swap_b32 v43, v51
  v_cvt_pk_bf16_f32 v64, v32, v33
  v_cvt_pk_bf16_f32 v65, v34, v35
  v_cvt_pk_bf16_f32 v66, v40, v41
  v_cvt_pk_bf16_f32 v67, v42, v43
  v_cvt_pk_bf16_f32 v68, v36, v37
  v_cvt_pk_bf16_f32 v69, v38, v39
  v_cvt_pk_bf16_f32 v72, v44, v45
  v_cvt_pk_bf16_f32 v73, v46, v47
  v_cvt_pk_bf16_f32 v74, v48, v49
  v_cvt_pk_bf16_f32 v75, v50, v51
  v_mov_b32 v70, v66
  v_mov_b32 v71, v67
  v_mfma_f32_16x16x32_bf16 v[40:43], v[72:75], v[168:171], 0
  v_mfma_f32_16x16x32_bf16 v[44:47], v[72:75], v[176:179], 0
  v_mfma_f32_16x16x32_bf16 v[32:35], v[64:67], v[168:171], 0
  v_mfma_f32_16x16x32_bf16 v[36:39], v[68:71], v[176:179], 0
  v_mfma_f32_16x16x32_bf16 v[56:59], v[72:75], v[172:175], 0
  v_mfma_f32_16x16x32_bf16 v[60:63], v[72:75], v[180:183], 0
  v_mfma_f32_16x16x32_bf16 v[48:51], v[64:67], v[172:175], 0
  v_mfma_f32_16x16x32_bf16 v[52:55], v[68:71], v[180:183], 0
  s_nop 1
  v_cndmask_b32_e64 v144, v40, v44, s[44:45]
  v_mov_b32 v146, v144
  s_nop 1
  v_permlane16_swap_b32 v144, v146
  v_mov_b32 v145, v144
  v_mov_b32 v147, v146
  s_nop 0
  v_permlane32_swap_b32 v144, v145
  v_permlane32_swap_b32 v146, v147
  v_add_f32 v144, s50, v144
  v_add_f32 v146, s50, v146
  v_rcp_f32 v144, v144
  v_rcp_f32 v146, v146
  v_pk_mul_f32 v[32:33], v[32:33], v[144:145] op_sel_hi:[1,0]
  v_pk_mul_f32 v[34:35], v[34:35], v[144:145] op_sel_hi:[1,0]
  v_pk_mul_f32 v[36:37], v[36:37], v[146:147] op_sel_hi:[1,0]
  v_pk_mul_f32 v[38:39], v[38:39], v[146:147] op_sel_hi:[1,0]
  v_pk_mul_f32 v[40:41], v[40:41], v[144:145] op_sel_hi:[1,0]
  v_pk_mul_f32 v[42:43], v[42:43], v[144:145] op_sel_hi:[1,0]
  v_pk_mul_f32 v[44:45], v[44:45], v[146:147] op_sel_hi:[1,0]
  v_pk_mul_f32 v[46:47], v[46:47], v[146:147] op_sel_hi:[1,0]
  v_cvt_pk_bf16_f32 v152, v32, v33
  v_cvt_pk_bf16_f32 v153, v34, v35
  v_cvt_pk_bf16_f32 v154, v36, v37
  v_cvt_pk_bf16_f32 v155, v38, v39
  buffer_store_dwordx4 v[152:155], v2, s[8:11], s70 offen sc1
  v_cndmask_b32_e64 v40, v44, v40, s[46:47]
  v_cndmask_b32_e64 v41, v45, v41, s[46:47]
  v_cndmask_b32_e64 v42, v46, v42, s[46:47]
  v_cndmask_b32_e64 v43, v47, v43, s[46:47]
  v_cvt_pk_bf16_f32 v160, v40, v41
  v_cvt_pk_bf16_f32 v161, v42, v43
  v_mov_b32 v164, v160
  v_mov_b32 v166, v160
  v_mov_b32 v165, v161
  v_mov_b32 v167, v161
  v_permlane16_swap_b32 v164, v166
  s_nop 0
  v_permlane16_swap_b32 v165, v167
  v_lshlrev_b32 v143, 4, v10
  s_mov_b32 exec_lo, 0x0
  s_mov_b32 exec_hi, 0xffff
  buffer_store_dwordx4 v[164:167], v143, s[8:11], s71 offen sc1
  s_mov_b64 exec, -1
  s_add_u32 s70, s70, 20480
  s_add_u32 s71, s71, 20480
  v_cndmask_b32_e64 v148, v56, v60, s[44:45]
  v_mov_b32 v150, v148
  s_nop 1
  v_permlane16_swap_b32 v148, v150
  v_mov_b32 v149, v148
  v_mov_b32 v151, v150
  s_nop 0
  v_permlane32_swap_b32 v148, v149
  v_permlane32_swap_b32 v150, v151
  v_add_f32 v148, s50, v148
  v_add_f32 v150, s50, v150
  v_rcp_f32 v148, v148
  v_rcp_f32 v150, v150
  v_pk_mul_f32 v[48:49], v[48:49], v[148:149] op_sel_hi:[1,0]
  v_pk_mul_f32 v[50:51], v[50:51], v[148:149] op_sel_hi:[1,0]
  v_pk_mul_f32 v[52:53], v[52:53], v[150:151] op_sel_hi:[1,0]
  v_pk_mul_f32 v[54:55], v[54:55], v[150:151] op_sel_hi:[1,0]
  v_pk_mul_f32 v[56:57], v[56:57], v[148:149] op_sel_hi:[1,0]
  v_pk_mul_f32 v[58:59], v[58:59], v[148:149] op_sel_hi:[1,0]
  v_pk_mul_f32 v[60:61], v[60:61], v[150:151] op_sel_hi:[1,0]
  v_pk_mul_f32 v[62:63], v[62:63], v[150:151] op_sel_hi:[1,0]
  v_cvt_pk_bf16_f32 v156, v48, v49
  v_cvt_pk_bf16_f32 v157, v50, v51
  v_cvt_pk_bf16_f32 v158, v52, v53
  v_cvt_pk_bf16_f32 v159, v54, v55
  buffer_store_dwordx4 v[156:159], v2, s[8:11], s70 offen sc1
  v_cndmask_b32_e64 v56, v60, v56, s[46:47]
  v_cndmask_b32_e64 v57, v61, v57, s[46:47]
  v_cndmask_b32_e64 v58, v62, v58, s[46:47]
  v_cndmask_b32_e64 v59, v63, v59, s[46:47]
  v_cvt_pk_bf16_f32 v162, v56, v57
  v_cvt_pk_bf16_f32 v163, v58, v59
  v_mov_b32 v168, v162
  v_mov_b32 v170, v162
  v_mov_b32 v169, v163
  v_mov_b32 v171, v163
  v_permlane16_swap_b32 v168, v170
  s_nop 0
  v_permlane16_swap_b32 v169, v171
  v_lshlrev_b32 v143, 4, v10
  s_mov_b32 exec_lo, 0x0
  s_mov_b32 exec_hi, 0xffff
  buffer_store_dwordx4 v[168:171], v143, s[8:11], s71 offen sc1
  s_mov_b64 exec, -1
  s_mul_i32 s60, s28, 131072
  s_add_u32 s60, s60, s84
  v_lshlrev_b32 v141, 10, v9
  v_mov_b32 v144, 1
  v_mov_b32 v145, 1
  v_mov_b32 v146, 1
  v_mov_b32 v147, 1
  s_waitcnt vmcnt(0) lgkmcnt(0)
  s_mov_b32 exec_lo, 0x10001
  s_mov_b32 exec_hi, 0x0
  buffer_store_dwordx4 v[144:147], v141, s[8:11], s60 offen sc1
  s_mov_b64 exec, -1
  s_barrier
  s_add_u32 s25, s25, 16
  s_mul_i32 s86, s28, 2621440
  s_add_u32 s36, s86, s83
  s_mul_i32 s60, s28, 131072
  s_add_u32 s60, s60, s85
  v_lshlrev_b32 v141, 6, v10
  s_mov_b32 s62, 0
L_ow_20:
  buffer_load_dword v250, v141, s[8:11], s60 offen sc1
  s_waitcnt vmcnt(0)
  v_cmp_eq_u32 vcc, 1, v250
  s_nop 4
  s_cmp_eq_u64 vcc, -1
  s_cbranch_scc1 L_owd_21
  s_add_u32 s62, s62, 1
  s_cmp_lt_u32 s62, 400000
  s_cbranch_scc1 L_ow_20
  v_mov_b32 v140, 0xdeaf
  v_mov_b32 v141, 0
  s_mov_b32 s62, 28619264
  buffer_store_dword v140, v141, s[8:11], s62 offen sc1
L_owd_21:
  buffer_load_dwordx4 a[0:3], v2, s[8:11], s36 offen offset:0 sc1
  buffer_load_dwordx4 a[4:7], v2, s[8:11], s36 offen offset:1024 sc1
  buffer_load_dwordx4 a[8:11], v2, s[8:11], s36 offen offset:2048 sc1
  buffer_load_dwordx4 a[12:15], v2, s[8:11], s36 offen offset:3072 sc1
  s_add_u32 s36, s36, 4096
  buffer_load_dwordx4 a[16:19], v2, s[8:11], s36 offen offset:0 sc1
  buffer_load_dwordx4 a[20:23], v2, s[8:11], s36 offen offset:1024 sc1
  buffer_load_dwordx4 a[24:27], v2, s[8:11], s36 offen offset:2048 sc1
  buffer_load_dwordx4 a[28:31], v2, s[8:11], s36 offen offset:3072 sc1
  s_add_u32 s36, s36, 4096
  buffer_load_dwordx4 a[32:35], v2, s[8:11], s36 offen offset:0 sc1
  buffer_load_dwordx4 a[36:39], v2, s[8:11], s36 offen offset:1024 sc1
  ds_read_b128 v[96:99], v3 offset:0
  ds_read_b128 v[100:103], v3 offset:1024
  ds_read_b128 v[104:107], v3 offset:2048
  ds_read_b128 v[108:111], v3 offset:3072
  ds_read_b128 v[112:115], v3 offset:4096
  s_waitcnt vmcnt(9)
  s_waitcnt lgkmcnt(4)
  v_mfma_f32_16x16x32_bf16 v[32:35], v[96:99], a[0:3], 0
  ds_read_b128 v[116:119], v3 offset:5120
  s_waitcnt lgkmcnt(4)
  v_mfma_f32_16x16x32_bf16 v[36:39], v[100:103], a[0:3], 0
  ds_read_b128 v[96:99], v3 offset:6144
  buffer_load_dwordx4 a[40:43], v2, s[8:11], s36 offen offset:2048 sc1
  s_waitcnt lgkmcnt(4)
  v_mfma_f32_16x16x32_bf16 v[40:43], v[104:107], a[0:3], 0
  ds_read_b128 v[100:103], v3 offset:7168
  s_waitcnt lgkmcnt(4)
  v_mfma_f32_16x16x32_bf16 v[44:47], v[108:111], a[0:3], 0
  ds_read_b128 v[104:107], v3 offset:8192
  s_waitcnt lgkmcnt(4)
  v_mfma_f32_16x16x32_bf16 v[48:51], v[112:115], a[0:3], 0
  ds_read_b128 v[108:111], v3 offset:9216
  s_waitcnt vmcnt(9)
  s_waitcnt lgkmcnt(4)
  v_mfma_f32_16x16x32_bf16 v[32:35], v[116:119], a[4:7], v[32:35]
  ds_read_b128 v[112:115], v3 offset:10240
  s_waitcnt lgkmcnt(4)
  v_mfma_f32_16x16x32_bf16 v[36:39], v[96:99], a[4:7], v[36:39]
  ds_read_b128 v[116:119], v3 offset:11264
  buffer_load_dwordx4 a[44:47], v2, s[8:11], s36 offen offset:3072 sc1
  s_waitcnt lgkmcnt(4)
  v_mfma_f32_16x16x32_bf16 v[40:43], v[100:103], a[4:7], v[40:43]
  ds_read_b128 v[96:99], v3 offset:12288
  s_waitcnt lgkmcnt(4)
  v_mfma_f32_16x16x32_bf16 v[44:47], v[104:107], a[4:7], v[44:47]
  ds_read_b128 v[100:103], v3 offset:13312
  s_waitcnt lgkmcnt(4)
  v_mfma_f32_16x16x32_bf16 v[48:51], v[108:111], a[4:7], v[48:51]
  ds_read_b128 v[104:107], v3 offset:14336
  s_waitcnt vmcnt(9)
  s_waitcnt lgkmcnt(4)
  v_mfma_f32_16x16x32_bf16 v[32:35], v[112:115], a[8:11], v[32:35]
  ds_read_b128 v[108:111], v3 offset:15360
  s_waitcnt lgkmcnt(4)
  v_mfma_f32_16x16x32_bf16 v[36:39], v[116:119], a[8:11], v[36:39]
  ds_read_b128 v[112:115], v3 offset:16384
  s_add_u32 s36, s36, 4096
  buffer_load_dwordx4 a[48:51], v2, s[8:11], s36 offen offset:0 sc1
  s_waitcnt lgkmcnt(4)
  v_mfma_f32_16x16x32_bf16 v[40:43], v[96:99], a[8:11], v[40:43]
  ds_read_b128 v[116:119], v3 offset:17408
  s_waitcnt lgkmcnt(4)
  v_mfma_f32_16x16x32_bf16 v[44:47], v[100:103], a[8:11], v[44:47]
  ds_read_b128 v[96:99], v3 offset:18432
  s_waitcnt lgkmcnt(4)
  v_mfma_f32_16x16x32_bf16 v[48:51], v[104:107], a[8:11], v[48:51]
  ds_read_b128 v[100:103], v3 offset:19456
  s_waitcnt vmcnt(9)
  s_waitcnt lgkmcnt(4)
  v_mfma_f32_16x16x32_bf16 v[32:35], v[108:111], a[12:15], v[32:35]
  ds_read_b128 v[104:107], v3 offset:20480
  s_waitcnt lgkmcnt(4)
  v_mfma_f32_16x16x32_bf16 v[36:39], v[112:115], a[12:15], v[36:39]
  ds_read_b128 v[108:111], v3 offset:21504
  buffer_load_dwordx4 a[52:55], v2, s[8:11], s36 offen offset:1024 sc1
  s_waitcnt lgkmcnt(4)
  v_mfma_f32_16x16x32_bf16 v[40:43], v[116:119], a[12:15], v[40:43]
  ds_read_b128 v[112:115], v3 offset:22528
  s_waitcnt lgkmcnt(4)
  v_mfma_f32_16x16x32_bf16 v[44:47], v[96:99], a[12:15], v[44:47]
  ds_read_b128 v[116:119], v3 offset:23552
  s_waitcnt lgkmcnt(4)
  v_mfma_f32_16x16x32_bf16 v[48:51], v[100:103], a[12:15], v[48:51]
  ds_read_b128 v[96:99], v3 offset:24576
  s_waitcnt vmcnt(9)
  s_waitcnt lgkmcnt(4)
  v_mfma_f32_16x16x32_bf16 v[32:35], v[104:107], a[16:19], v[32:35]
  ds_read_b128 v[100:103], v3 offset:25600
  s_waitcnt lgkmcnt(4)
  v_mfma_f32_16x16x32_bf16 v[36:39], v[108:111], a[16:19], v[36:39]
  ds_read_b128 v[104:107], v3 offset:26624
  buffer_load_dwordx4 a[56:59], v2, s[8:11], s36 offen offset:2048 sc1
  s_waitcnt lgkmcnt(4)
  v_mfma_f32_16x16x32_bf16 v[40:43], v[112:115], a[16:19], v[40:43]
  ds_read_b128 v[108:111], v3 offset:27648
  s_waitcnt lgkmcnt(4)
  v_mfma_f32_16x16x32_bf16 v[44:47], v[116:119], a[16:19], v[44:47]
  ds_read_b128 v[112:115], v3 offset:28672
  s_waitcnt lgkmcnt(4)
  v_mfma_f32_16x16x32_bf16 v[48:51], v[96:99], a[16:19], v[48:51]
  ds_read_b128 v[116:119], v3 offset:29696
  s_waitcnt vmcnt(9)
  s_waitcnt lgkmcnt(4)
  v_mfma_f32_16x16x32_bf16 v[32:35], v[100:103], a[20:23], v[32:35]
  ds_read_b128 v[96:99], v3 offset:30720
  s_waitcnt lgkmcnt(4)
  v_mfma_f32_16x16x32_bf16 v[36:39], v[104:107], a[20:23], v[36:39]
  ds_read_b128 v[100:103], v3 offset:31744
  buffer_load_dwordx4 a[60:63], v2, s[8:11], s36 offen offset:3072 sc1
  s_waitcnt lgkmcnt(4)
  v_mfma_f32_16x16x32_bf16 v[40:43], v[108:111], a[20:23], v[40:43]
  ds_read_b128 v[104:107], v3 offset:32768
  s_waitcnt lgkmcnt(4)
  v_mfma_f32_16x16x32_bf16 v[44:47], v[112:115], a[20:23], v[44:47]
  ds_read_b128 v[108:111], v3 offset:33792
  s_waitcnt lgkmcnt(4)
  v_mfma_f32_16x16x32_bf16 v[48:51], v[116:119], a[20:23], v[48:51]
  ds_read_b128 v[112:115], v3 offset:34816
  s_waitcnt vmcnt(9)
  s_waitcnt lgkmcnt(4)
  v_mfma_f32_16x16x32_bf16 v[32:35], v[96:99], a[24:27], v[32:35]
  ds_read_b128 v[116:119], v3 offset:35840
  s_waitcnt lgkmcnt(4)
  v_mfma_f32_16x16x32_bf16 v[36:39], v[100:103], a[24:27], v[36:39]
  ds_read_b128 v[96:99], v3 offset:36864
  s_add_u32 s36, s36, 4096
  buffer_load_dwordx4 a[64:67], v2, s[8:11], s36 offen offset:0 sc1
  s_waitcnt lgkmcnt(4)
  v_mfma_f32_16x16x32_bf16 v[40:43], v[104:107], a[24:27], v[40:43]
  ds_read_b128 v[100:103], v3 offset:37888
  s_waitcnt lgkmcnt(4)
  v_mfma_f32_16x16x32_bf16 v[44:47], v[108:111], a[24:27], v[44:47]
  ds_read_b128 v[104:107], v3 offset:38912
  s_waitcnt lgkmcnt(4)
  v_mfma_f32_16x16x32_bf16 v[48:51], v[112:115], a[24:27], v[48:51]
  ds_read_b128 v[108:111], v3 offset:39936
  s_waitcnt vmcnt(9)
  s_waitcnt lgkmcnt(4)
  v_mfma_f32_16x16x32_bf16 v[32:35], v[116:119], a[28:31], v[32:35]
  ds_read_b128 v[112:115], v3 offset:40960
  s_waitcnt lgkmcnt(4)
  v_mfma_f32_16x16x32_bf16 v[36:39], v[96:99], a[28:31], v[36:39]
  ds_read_b128 v[116:119], v3 offset:41984
  buffer_load_dwordx4 a[68:71], v2, s[8:11], s36 offen offset:1024 sc1
  s_waitcnt lgkmcnt(4)
  v_mfma_f32_16x16x32_bf16 v[40:43], v[100:103], a[28:31], v[40:43]
  ds_read_b128 v[96:99], v3 offset:43008
  s_waitcnt lgkmcnt(4)
  v_mfma_f32_16x16x32_bf16 v[44:47], v[104:107], a[28:31], v[44:47]
  ds_read_b128 v[100:103], v3 offset:44032
  s_waitcnt lgkmcnt(4)
  v_mfma_f32_16x16x32_bf16 v[48:51], v[108:111], a[28:31], v[48:51]
  ds_read_b128 v[104:107], v3 offset:45056
  s_waitcnt vmcnt(9)
  s_waitcnt lgkmcnt(4)
  v_mfma_f32_16x16x32_bf16 v[32:35], v[112:115], a[32:35], v[32:35]
  ds_read_b128 v[108:111], v3 offset:46080
  s_waitcnt lgkmcnt(4)
  v_mfma_f32_16x16x32_bf16 v[36:39], v[116:119], a[32:35], v[36:39]
  ds_read_b128 v[112:115], v3 offset:47104
  buffer_load_dwordx4 a[72:75], v2, s[8:11], s36 offen offset:2048 sc1
  s_waitcnt lgkmcnt(4)
  v_mfma_f32_16x16x32_bf16 v[40:43], v[96:99], a[32:35], v[40:43]
  ds_read_b128 v[116:119], v3 offset:48128
  s_waitcnt lgkmcnt(4)
  v_mfma_f32_16x16x32_bf16 v[44:47], v[100:103], a[32:35], v[44:47]
  ds_read_b128 v[96:99], v3 offset:49152
  s_waitcnt lgkmcnt(4)
  v_mfma_f32_16x16x32_bf16 v[48:51], v[104:107], a[32:35], v[48:51]
  ds_read_b128 v[100:103], v3 offset:50176
  s_waitcnt vmcnt(9)
  s_waitcnt lgkmcnt(4)
  v_mfma_f32_16x16x32_bf16 v[32:35], v[108:111], a[36:39], v[32:35]
  ds_read_b128 v[104:107], v4 offset:36864
  s_waitcnt lgkmcnt(4)
  v_mfma_f32_16x16x32_bf16 v[36:39], v[112:115], a[36:39], v[36:39]
  ds_read_b128 v[108:111], v4 offset:37888
  buffer_load_dwordx4 a[76:79], v2, s[8:11], s36 offen offset:3072 sc1
  s_mul_i32 s35, s3, 12
  s_min_u32 s35, s35, 36
  s_lshl_b32 s35, s35, 10
  s_add_u32 s34, s31, s35
  s_add_u32 s35, s35, 51200
  s_mov_b32 m0, s35
  s_nop 0
  buffer_load_dwordx4 v2, s[8:11], s34 offen offset:0 lds
  s_waitcnt lgkmcnt(4)
  v_mfma_f32_16x16x32_bf16 v[40:43], v[116:119], a[36:39], v[40:43]
  ds_read_b128 v[112:115], v4 offset:38912
  s_waitcnt lgkmcnt(4)
  v_mfma_f32_16x16x32_bf16 v[44:47], v[96:99], a[36:39], v[44:47]
  ds_read_b128 v[116:119], v4 offset:39936
  s_waitcnt lgkmcnt(4)
  v_mfma_f32_16x16x32_bf16 v[48:51], v[100:103], a[36:39], v[48:51]
  ds_read_b128 v[96:99], v4 offset:40960
  s_waitcnt vmcnt(10)
  s_waitcnt lgkmcnt(4)
  v_mfma_f32_16x16x32_bf16 v[32:35], v[104:107], a[40:43], v[32:35]
  ds_read_b128 v[100:103], v4 offset:41984
  buffer_load_dwordx4 v2, s[8:11], s34 offen offset:1024 lds
  s_waitcnt lgkmcnt(4)
  v_mfma_f32_16x16x32_bf16 v[36:39], v[108:111], a[40:43], v[36:39]
  ds_read_b128 v[104:107], v4 offset:43008
  s_waitcnt lgkmcnt(4)
  v_mfma_f32_16x16x32_bf16 v[40:43], v[112:115], a[40:43], v[40:43]
  ds_read_b128 v[108:111], v4 offset:44032
  s_waitcnt lgkmcnt(4)
  v_mfma_f32_16x16x32_bf16 v[44:47], v[116:119], a[40:43], v[44:47]
  ds_read_b128 v[112:115], v4 offset:45056
  s_waitcnt lgkmcnt(4)
  v_mfma_f32_16x16x32_bf16 v[48:51], v[96:99], a[40:43], v[48:51]
  ds_read_b128 v[116:119], v4 offset:46080
  buffer_load_dwordx4 v2, s[8:11], s34 offen offset:2048 lds
  s_waitcnt vmcnt(11)
  s_waitcnt lgkmcnt(4)
  v_mfma_f32_16x16x32_bf16 v[32:35], v[100:103], a[44:47], v[32:35]
  ds_read_b128 v[96:99], v4 offset:47104
  s_waitcnt lgkmcnt(4)
  v_mfma_f32_16x16x32_bf16 v[36:39], v[104:107], a[44:47], v[36:39]
  ds_read_b128 v[100:103], v4 offset:48128
  s_waitcnt lgkmcnt(4)
  v_mfma_f32_16x16x32_bf16 v[40:43], v[108:111], a[44:47], v[40:43]
  ds_read_b128 v[104:107], v4 offset:49152
  s_waitcnt lgkmcnt(4)
  v_mfma_f32_16x16x32_bf16 v[44:47], v[112:115], a[44:47], v[44:47]
  ds_read_b128 v[108:111], v4 offset:50176
  buffer_load_dwordx4 v2, s[8:11], s34 offen offset:3072 lds
  s_waitcnt lgkmcnt(4)
  v_mfma_f32_16x16x32_bf16 v[48:51], v[116:119], a[44:47], v[48:51]
  ds_read_b128 v[112:115], v4 offset:51200
  s_waitcnt vmcnt(11)
  s_waitcnt lgkmcnt(4)
  v_mfma_f32_16x16x32_bf16 v[32:35], v[96:99], a[48:51], v[32:35]
  ds_read_b128 v[116:119], v4 offset:52224
  s_waitcnt lgkmcnt(4)
  v_mfma_f32_16x16x32_bf16 v[36:39], v[100:103], a[48:51], v[36:39]
  ds_read_b128 v[96:99], v4 offset:53248
  s_waitcnt lgkmcnt(4)
  v_mfma_f32_16x16x32_bf16 v[40:43], v[104:107], a[48:51], v[40:43]
  ds_read_b128 v[100:103], v4 offset:54272
  s_add_u32 s35, s35, 4096
  s_add_u32 s34, s34, 4096
  s_mov_b32 m0, s35
  s_nop 0
  buffer_load_dwordx4 v2, s[8:11], s34 offen offset:0 lds
  s_waitcnt lgkmcnt(4)
  v_mfma_f32_16x16x32_bf16 v[44:47], v[108:111], a[48:51], v[44:47]
  ds_read_b128 v[104:107], v4 offset:55296
  s_waitcnt lgkmcnt(4)
  v_mfma_f32_16x16x32_bf16 v[48:51], v[112:115], a[48:51], v[48:51]
  ds_read_b128 v[108:111], v4 offset:56320
  s_waitcnt vmcnt(11)
  s_waitcnt lgkmcnt(4)
  v_mfma_f32_16x16x32_bf16 v[32:35], v[116:119], a[52:55], v[32:35]
  ds_read_b128 v[112:115], v4 offset:57344
  s_waitcnt lgkmcnt(4)
  v_mfma_f32_16x16x32_bf16 v[36:39], v[96:99], a[52:55], v[36:39]
  ds_read_b128 v[116:119], v4 offset:58368
  buffer_load_dwordx4 v2, s[8:11], s34 offen offset:1024 lds
  s_waitcnt lgkmcnt(4)
  v_mfma_f32_16x16x32_bf16 v[40:43], v[100:103], a[52:55], v[40:43]
  ds_read_b128 v[96:99], v4 offset:59392
  s_waitcnt lgkmcnt(4)
  v_mfma_f32_16x16x32_bf16 v[44:47], v[104:107], a[52:55], v[44:47]
  ds_read_b128 v[100:103], v4 offset:60416
  s_waitcnt lgkmcnt(4)
  v_mfma_f32_16x16x32_bf16 v[48:51], v[108:111], a[52:55], v[48:51]
  ds_read_b128 v[104:107], v4 offset:61440
  s_waitcnt vmcnt(11)
  s_waitcnt lgkmcnt(4)
  v_mfma_f32_16x16x32_bf16 v[32:35], v[112:115], a[56:59], v[32:35]
  ds_read_b128 v[108:111], v4 offset:62464
  buffer_load_dwordx4 v2, s[8:11], s34 offen offset:2048 lds
  s_waitcnt lgkmcnt(4)
  v_mfma_f32_16x16x32_bf16 v[36:39], v[116:119], a[56:59], v[36:39]
  ds_read_b128 v[112:115], v4 offset:63488
  s_waitcnt lgkmcnt(4)
  v_mfma_f32_16x16x32_bf16 v[40:43], v[96:99], a[56:59], v[40:43]
  ds_read_b128 v[116:119], v4 offset:64512
  s_waitcnt lgkmcnt(4)
  v_mfma_f32_16x16x32_bf16 v[44:47], v[100:103], a[56:59], v[44:47]
  ds_read_b128 v[96:99], v5 offset:0
  s_waitcnt lgkmcnt(4)
  v_mfma_f32_16x16x32_bf16 v[48:51], v[104:107], a[56:59], v[48:51]
  ds_read_b128 v[100:103], v5 offset:1024
  buffer_load_dwordx4 v2, s[8:11], s34 offen offset:3072 lds
  s_waitcnt vmcnt(12)
  s_waitcnt lgkmcnt(4)
  v_mfma_f32_16x16x32_bf16 v[32:35], v[108:111], a[60:63], v[32:35]
  ds_read_b128 v[104:107], v5 offset:2048
  s_waitcnt lgkmcnt(4)
  v_mfma_f32_16x16x32_bf16 v[36:39], v[112:115], a[60:63], v[36:39]
  ds_read_b128 v[108:111], v5 offset:3072
  s_waitcnt lgkmcnt(4)
  v_mfma_f32_16x16x32_bf16 v[40:43], v[116:119], a[60:63], v[40:43]
  ds_read_b128 v[112:115], v5 offset:4096
  s_waitcnt lgkmcnt(4)
  v_mfma_f32_16x16x32_bf16 v[44:47], v[96:99], a[60:63], v[44:47]
  ds_read_b128 v[116:119], v5 offset:5120
  s_add_u32 s35, s35, 4096
  s_add_u32 s34, s34, 4096
  s_mov_b32 m0, s35
  s_nop 0
  buffer_load_dwordx4 v2, s[8:11], s34 offen offset:0 lds
  s_waitcnt lgkmcnt(4)
  v_mfma_f32_16x16x32_bf16 v[48:51], v[100:103], a[60:63], v[48:51]
  ds_read_b128 v[96:99], v5 offset:6144
  s_waitcnt vmcnt(12)
  s_waitcnt lgkmcnt(4)
  v_mfma_f32_16x16x32_bf16 v[32:35], v[104:107], a[64:67], v[32:35]
  ds_read_b128 v[100:103], v5 offset:7168
  s_waitcnt lgkmcnt(4)
  v_mfma_f32_16x16x32_bf16 v[36:39], v[108:111], a[64:67], v[36:39]
  ds_read_b128 v[104:107], v5 offset:8192
  s_waitcnt lgkmcnt(4)
  v_mfma_f32_16x16x32_bf16 v[40:43], v[112:115], a[64:67], v[40:43]
  ds_read_b128 v[108:111], v5 offset:9216
  buffer_load_dwordx4 v2, s[8:11], s34 offen offset:1024 lds
  s_waitcnt lgkmcnt(4)
  v_mfma_f32_16x16x32_bf16 v[44:47], v[116:119], a[64:67], v[44:47]
  ds_read_b128 v[112:115], v5 offset:10240
  s_waitcnt lgkmcnt(4)
  v_mfma_f32_16x16x32_bf16 v[48:51], v[96:99], a[64:67], v[48:51]
  ds_read_b128 v[116:119], v5 offset:11264
  s_waitcnt vmcnt(12)
  s_waitcnt lgkmcnt(4)
  v_mfma_f32_16x16x32_bf16 v[32:35], v[100:103], a[68:71], v[32:35]
  ds_read_b128 v[96:99], v5 offset:12288
  s_waitcnt lgkmcnt(4)
  v_mfma_f32_16x16x32_bf16 v[36:39], v[104:107], a[68:71], v[36:39]
  ds_read_b128 v[100:103], v5 offset:13312
  buffer_load_dwordx4 v2, s[8:11], s34 offen offset:2048 lds
  s_waitcnt lgkmcnt(4)
  v_mfma_f32_16x16x32_bf16 v[40:43], v[108:111], a[68:71], v[40:43]
  ds_read_b128 v[104:107], v5 offset:14336
  s_waitcnt lgkmcnt(4)
  v_mfma_f32_16x16x32_bf16 v[44:47], v[112:115], a[68:71], v[44:47]
  ds_read_b128 v[108:111], v5 offset:15360
  s_waitcnt lgkmcnt(4)
  v_mfma_f32_16x16x32_bf16 v[48:51], v[116:119], a[68:71], v[48:51]
  ds_read_b128 v[112:115], v5 offset:16384
  s_waitcnt vmcnt(12)
  s_waitcnt lgkmcnt(4)
  v_mfma_f32_16x16x32_bf16 v[32:35], v[96:99], a[72:75], v[32:35]
  ds_read_b128 v[116:119], v5 offset:17408
  buffer_load_dwordx4 v2, s[8:11], s34 offen offset:3072 lds
  s_waitcnt lgkmcnt(4)
  v_mfma_f32_16x16x32_bf16 v[36:39], v[100:103], a[72:75], v[36:39]
  ds_read_b128 v[96:99], v5 offset:18432
  s_waitcnt lgkmcnt(4)
  v_mfma_f32_16x16x32_bf16 v[40:43], v[104:107], a[72:75], v[40:43]
  ds_read_b128 v[100:103], v5 offset:19456
  s_waitcnt lgkmcnt(4)
  v_mfma_f32_16x16x32_bf16 v[44:47], v[108:111], a[72:75], v[44:47]
  ds_read_b128 v[104:107], v5 offset:20480
  s_waitcnt lgkmcnt(4)
  v_mfma_f32_16x16x32_bf16 v[48:51], v[112:115], a[72:75], v[48:51]
  ds_read_b128 v[108:111], v5 offset:21504
  s_waitcnt vmcnt(12)
  s_waitcnt lgkmcnt(4)
  v_mfma_f32_16x16x32_bf16 v[32:35], v[116:119], a[76:79], v[32:35]
  s_waitcnt lgkmcnt(3)
  v_mfma_f32_16x16x32_bf16 v[36:39], v[96:99], a[76:79], v[36:39]
  s_waitcnt lgkmcnt(2)
  v_mfma_f32_16x16x32_bf16 v[40:43], v[100:103], a[76:79], v[40:43]
  s_waitcnt lgkmcnt(1)
  v_mfma_f32_16x16x32_bf16 v[44:47], v[104:107], a[76:79], v[44:47]
  s_waitcnt lgkmcnt(0)
  v_mfma_f32_16x16x32_bf16 v[48:51], v[108:111], a[76:79], v[48:51]
  v_pk_add_f32 v[32:33], v[32:33], v[12:13]
  v_pk_add_f32 v[34:35], v[34:35], v[14:15]
  v_pk_add_f32 v[36:37], v[36:37], v[16:17]
  v_pk_add_f32 v[38:39], v[38:39], v[18:19]
  v_pk_add_f32 v[40:41], v[40:41], v[20:21]
  v_pk_add_f32 v[42:43], v[42:43], v[22:23]
  v_pk_add_f32 v[44:45], v[44:45], v[24:25]
  v_pk_add_f32 v[46:47], v[46:47], v[26:27]
  v_pk_add_f32 v[48:49], v[48:49], v[28:29]
  v_pk_add_f32 v[50:51], v[50:51], v[30:31]
  v_cvt_pk_bf16_f32 v144, v32, v33
  v_cvt_pk_bf16_f32 v145, v34, v35
  v_cvt_pk_bf16_f32 v146, v36, v37
  v_cvt_pk_bf16_f32 v147, v38, v39
  v_cvt_pk_bf16_f32 v148, v40, v41
  v_cvt_pk_bf16_f32 v149, v42, v43
  v_cvt_pk_bf16_f32 v150, v44, v45
  v_cvt_pk_bf16_f32 v151, v46, v47
  v_cvt_pk_bf16_f32 v152, v48, v49
  v_cvt_pk_bf16_f32 v153, v50, v51
  s_add_u32 s61, s86, s80
  s_mov_b32 s70, s61
  buffer_store_dwordx4 v[144:147], v2, s[8:11], s61 offen sc1
  buffer_store_dwordx4 v[148:151], v2, s[8:11], s61 offen offset:1024 sc1
  s_add_u32 s61, s86, s81
  v_lshrrev_b32 v141, 1, v9
  v_lshlrev_b32 v141, 8, v141
  v_lshl_add_u32 v141, v10, 4, v141
  v_mov_b32 v172, v152
  v_mov_b32 v174, v152
  v_mov_b32 v173, v153
  v_mov_b32 v175, v153
  v_permlane16_swap_b32 v172, v174
  s_nop 0
  v_permlane16_swap_b32 v173, v175
  s_mov_b32 exec_lo, 0xffff
  s_mov_b32 exec_hi, 0xffff
  buffer_store_dwordx4 v[172:175], v141, s[8:11], s61 offen sc1
  s_mov_b64 exec, -1
  s_mov_b32 s71, s61
  v_mov_b32 v170, v141
  v_lshlrev_b32 v12, 16, v144
  v_and_b32 v13, 0xffff0000, v144
  v_lshlrev_b32 v14, 16, v145
  v_and_b32 v15, 0xffff0000, v145
  v_lshlrev_b32 v16, 16, v146
  v_and_b32 v17, 0xffff0000, v146
  v_lshlrev_b32 v18, 16, v147
  v_and_b32 v19, 0xffff0000, v147
  v_lshlrev_b32 v20, 16, v148
  v_and_b32 v21, 0xffff0000, v148
  v_lshlrev_b32 v22, 16, v149
  v_and_b32 v23, 0xffff0000, v149
  v_lshlrev_b32 v24, 16, v150
  v_and_b32 v25, 0xffff0000, v150
  v_lshlrev_b32 v26, 16, v151
  v_and_b32 v27, 0xffff0000, v151
  v_lshlrev_b32 v28, 16, v152
  v_and_b32 v29, 0xffff0000, v152
  v_lshlrev_b32 v30, 16, v153
  v_and_b32 v31, 0xffff0000, v153
  v_pk_add_f32 v[156:157], v[12:13], v[14:15]
  v_pk_mul_f32 v[158:159], v[12:13], v[12:13]
  v_pk_fma_f32 v[158:159], v[14:15], v[14:15], v[158:159]
  v_pk_add_f32 v[156:157], v[156:157], v[16:17]
  v_pk_fma_f32 v[158:159], v[16:17], v[16:17], v[158:159]
  v_pk_add_f32 v[156:157], v[156:157], v[18:19]
  v_pk_fma_f32 v[158:159], v[18:19], v[18:19], v[158:159]
  v_pk_add_f32 v[156:157], v[156:157], v[20:21]
  v_pk_fma_f32 v[158:159], v[20:21], v[20:21], v[158:159]
  v_pk_add_f32 v[156:157], v[156:157], v[22:23]
  v_pk_fma_f32 v[158:159], v[22:23], v[22:23], v[158:159]
  v_pk_add_f32 v[156:157], v[156:157], v[24:25]
  v_pk_fma_f32 v[158:159], v[24:25], v[24:25], v[158:159]
  v_pk_add_f32 v[156:157], v[156:157], v[26:27]
  v_pk_fma_f32 v[158:159], v[26:27], v[26:27], v[158:159]
  v_pk_add_f32 v[156:157], v[156:157], v[28:29]
  v_pk_fma_f32 v[158:159], v[28:29], v[28:29], v[158:159]
  v_pk_add_f32 v[156:157], v[156:157], v[30:31]
  v_pk_fma_f32 v[158:159], v[30:31], v[30:31], v[158:159]
  v_add_f32 v156, v156, v157
  v_add_f32 v157, v158, v159
  v_mov_b32 v160, v156
  v_mov_b32 v161, v157
  s_nop 0
  v_permlane32_swap_b32 v156, v160
  v_permlane32_swap_b32 v157, v161
  v_add_f32 v156, v156, v160
  v_add_f32 v157, v157, v161
  v_mov_b32 v160, v156
  v_mov_b32 v161, v157
  s_nop 0
  v_permlane16_swap_b32 v156, v160
  v_permlane16_swap_b32 v157, v161
  v_add_f32 v156, v156, v160
  v_add_f32 v157, v157, v161
  s_mul_i32 s60, s28, 131072
  s_add_u32 s60, s60, s82
  v_lshlrev_b32 v141, 3, v10
  v_mov_b32_dpp v158, v156 quad_perm:[1,0,3,2] row_mask:0xf bank_mask:0xf
  v_mov_b32_dpp v159, v157 quad_perm:[1,0,3,2] row_mask:0xf bank_mask:0xf
  s_waitcnt vmcnt(0) lgkmcnt(0)
  s_mov_b32 exec_lo, 0x5555
  s_mov_b32 exec_hi, 0x0
  buffer_store_dwordx4 v[156:159], v141, s[8:11], s60 offen sc1
  s_mov_b64 exec, -1
  s_barrier
  s_add_u32 s25, s25, 16
  s_lshl_b32 s28, s24, 1
  s_add_u32 s28, s28, 1
  s_mul_i32 s60, s28, 2621440
  s_lshl_b32 s61, s20, 3
  s_lshl_b32 s62, s3, 1
  s_add_u32 s61, s61, s62
  s_mul_i32 s61, s61, 20480
  s_add_u32 s60, s60, s61
  s_add_u32 s36, s60, 6881280
  s_add_u32 s37, s36, 20480
  s_mul_i32 s60, s28, 131072
  s_lshl_b32 s61, s20, 13
  s_add_u32 s60, s60, s61
  s_lshl_b32 s61, s3, 11
  s_add_u32 s60, s60, s61
  s_add_u32 s65, s60, 27852800
  s_mul_i32 s35, s3, 3
  s_min_u32 s35, s35, 9
  s_lshl_b32 s35, s35, 10
  s_add_u32 s34, s31, s35
  s_add_u32 s34, s34, 49152
  s_add_u32 s35, s35, 102400
  s_mov_b32 m0, s35
  s_nop 0
  buffer_load_dwordx4 v2, s[8:11], s34 offen offset:0 lds
  buffer_load_dwordx4 v2, s[8:11], s34 offen offset:1024 lds
  buffer_load_dwordx4 v2, s[8:11], s34 offen offset:2048 lds
  s_mul_i32 s35, s3, 13
  s_min_u32 s35, s35, 37
  s_lshl_b32 s35, s35, 10
  s_add_u32 s34, s31, s35
  s_add_u32 s34, s34, 61440
  s_mov_b32 m0, s35
  s_nop 0
  buffer_load_dwordx4 v2, s[8:11], s34 offen offset:0 lds
  buffer_load_dwordx4 v2, s[8:11], s34 offen offset:1024 lds
  buffer_load_dwordx4 v2, s[8:11], s34 offen offset:2048 lds
  buffer_load_dwordx4 v2, s[8:11], s34 offen offset:3072 lds
  s_add_u32 s35, s35, 4096
  s_add_u32 s34, s34, 4096
  s_mov_b32 m0, s35
  s_nop 0
  buffer_load_dwordx4 v2, s[8:11], s34 offen offset:0 lds
  buffer_load_dwordx4 v2, s[8:11], s34 offen offset:1024 lds
  buffer_load_dwordx4 v2, s[8:11], s34 offen offset:2048 lds
  buffer_load_dwordx4 v2, s[8:11], s34 offen offset:3072 lds
  s_add_u32 s35, s35, 4096
  s_add_u32 s34, s34, 4096
  s_mov_b32 m0, s35
  s_nop 0
  buffer_load_dwordx4 v2, s[8:11], s34 offen offset:0 lds
  buffer_load_dwordx4 v2, s[8:11], s34 offen offset:1024 lds
  buffer_load_dwordx4 v2, s[8:11], s34 offen offset:2048 lds
  buffer_load_dwordx4 v2, s[8:11], s34 offen offset:3072 lds
  s_add_u32 s35, s35, 4096
  s_add_u32 s34, s34, 4096
  s_mov_b32 m0, s35
  s_nop 0
  buffer_load_dwordx4 v2, s[8:11], s34 offen offset:0 lds
  s_mov_b32 s62, 0
L_xw_24:
  buffer_load_dwordx2 v[208:209], v11, s[8:11], s65 offen offset:0 sc1
  buffer_load_dwordx2 v[210:211], v11, s[8:11], s65 offen offset:512 sc1
  buffer_load_dwordx2 v[212:213], v11, s[8:11], s65 offen offset:1024 sc1
  buffer_load_dwordx2 v[214:215], v11, s[8:11], s65 offen offset:1536 sc1
  s_waitcnt vmcnt(0)
  v_cmp_ne_u32 vcc, -1, v209
  v_cmp_ne_u32 s[56:57], -1, v211
  s_nop 1
  s_and_b64 vcc, vcc, s[56:57]
  v_cmp_ne_u32 s[56:57], -1, v213
  s_nop 1
  s_and_b64 vcc, vcc, s[56:57]
  v_cmp_ne_u32 s[56:57], -1, v215
  s_nop 1
  s_and_b64 vcc, vcc, s[56:57]
  s_nop 1
  s_cmp_eq_u64 vcc, -1
  s_cbranch_scc1 L_xwd_25
  s_add_u32 s62, s62, 1
  s_cmp_lt_u32 s62, 400000
  s_cbranch_scc1 L_xw_24
  v_mov_b32 v140, 0xdeaf
  v_mov_b32 v141, 0
  s_mov_b32 s62, 28619264
  buffer_store_dword v140, v141, s[8:11], s62 offen sc1
L_xwd_25:
  s_barrier
  buffer_load_dwordx4 a[0:3], v2, s[8:11], s36 offen offset:0 sc1
  buffer_load_dwordx4 a[4:7], v2, s[8:11], s37 offen offset:0 sc1
  buffer_load_dwordx4 a[8:11], v2, s[8:11], s36 offen offset:1024 sc1
  buffer_load_dwordx4 a[12:15], v2, s[8:11], s37 offen offset:1024 sc1
  buffer_load_dwordx4 a[16:19], v2, s[8:11], s36 offen offset:2048 sc1
  buffer_load_dwordx4 a[20:23], v2, s[8:11], s37 offen offset:2048 sc1
  buffer_load_dwordx4 a[24:27], v2, s[8:11], s36 offen offset:3072 sc1
  buffer_load_dwordx4 a[28:31], v2, s[8:11], s37 offen offset:3072 sc1
  s_add_u32 s36, s36, 4096
  s_add_u32 s37, s37, 4096
  buffer_load_dwordx4 a[32:35], v2, s[8:11], s36 offen offset:0 sc1
  buffer_load_dwordx4 a[36:39], v2, s[8:11], s37 offen offset:0 sc1
  ds_read_b128 v[96:99], v3 offset:51200
  ds_read_b128 v[100:103], v3 offset:52224
  ds_read_b128 v[104:107], v3 offset:53248
  ds_read_b128 v[108:111], v3 offset:54272
  ds_read_b128 v[112:115], v3 offset:55296
  s_waitcnt vmcnt(8)
  s_waitcnt lgkmcnt(4)
  v_mfma_f32_16x16x32_bf16 v[32:35], v[96:99], a[0:3], 0
  ds_read_b128 v[116:119], v3 offset:56320
  v_mfma_f32_16x16x32_bf16 v[36:39], v[96:99], a[4:7], 0
  s_waitcnt lgkmcnt(4)
  v_mfma_f32_16x16x32_bf16 v[40:43], v[100:103], a[0:3], 0
  ds_read_b128 v[96:99], v3 offset:57344
  buffer_load_dwordx4 a[40:43], v2, s[8:11], s36 offen offset:1024 sc1
  v_mfma_f32_16x16x32_bf16 v[44:47], v[100:103], a[4:7], 0
  s_waitcnt lgkmcnt(4)
  v_mfma_f32_16x16x32_bf16 v[48:51], v[104:107], a[0:3], 0
  ds_read_b128 v[100:103], v3 offset:58368
  buffer_load_dwordx4 a[44:47], v2, s[8:11], s37 offen offset:1024 sc1
  v_mfma_f32_16x16x32_bf16 v[52:55], v[104:107], a[4:7], 0
  s_waitcnt vmcnt(8)
  s_waitcnt lgkmcnt(4)
  v_mfma_f32_16x16x32_bf16 v[32:35], v[108:111], a[8:11], v[32:35]
  ds_read_b128 v[104:107], v3 offset:59392
  buffer_load_dwordx4 a[48:51], v2, s[8:11], s36 offen offset:2048 sc1
  v_mfma_f32_16x16x32_bf16 v[36:39], v[108:111], a[12:15], v[36:39]
  s_waitcnt lgkmcnt(4)
  v_mfma_f32_16x16x32_bf16 v[40:43], v[112:115], a[8:11], v[40:43]
  ds_read_b128 v[108:111], v3 offset:60416
  v_mfma_f32_16x16x32_bf16 v[44:47], v[112:115], a[12:15], v[44:47]
  s_waitcnt lgkmcnt(4)
  v_mfma_f32_16x16x32_bf16 v[48:51], v[116:119], a[8:11], v[48:51]
  ds_read_b128 v[112:115], v3 offset:61440
  buffer_load_dwordx4 a[52:55], v2, s[8:11], s37 offen offset:2048 sc1
  v_mfma_f32_16x16x32_bf16 v[52:55], v[116:119], a[12:15], v[52:55]
  s_waitcnt vmcnt(8)
  s_waitcnt lgkmcnt(4)
  v_mfma_f32_16x16x32_bf16 v[32:35], v[96:99], a[16:19], v[32:35]
  ds_read_b128 v[116:119], v3 offset:62464
  buffer_load_dwordx4 a[56:59], v2, s[8:11], s36 offen offset:3072 sc1
  v_mfma_f32_16x16x32_bf16 v[36:39], v[96:99], a[20:23], v[36:39]
  s_waitcnt lgkmcnt(4)
  v_mfma_f32_16x16x32_bf16 v[40:43], v[100:103], a[16:19], v[40:43]
  ds_read_b128 v[96:99], v3 offset:63488
  buffer_load_dwordx4 a[60:63], v2, s[8:11], s37 offen offset:3072 sc1
  v_mfma_f32_16x16x32_bf16 v[44:47], v[100:103], a[20:23], v[44:47]
  s_waitcnt lgkmcnt(4)
  v_mfma_f32_16x16x32_bf16 v[48:51], v[104:107], a[16:19], v[48:51]
  ds_read_b128 v[100:103], v3 offset:64512
  v_mfma_f32_16x16x32_bf16 v[52:55], v[104:107], a[20:23], v[52:55]
  s_waitcnt vmcnt(8)
  s_waitcnt lgkmcnt(4)
  v_mfma_f32_16x16x32_bf16 v[32:35], v[108:111], a[24:27], v[32:35]
  ds_read_b128 v[104:107], v4 offset:0
  s_add_u32 s36, s36, 4096
  v_mfma_f32_16x16x32_bf16 v[36:39], v[108:111], a[28:31], v[36:39]
  s_waitcnt lgkmcnt(4)
  s_add_u32 s37, s37, 4096
  v_mfma_f32_16x16x32_bf16 v[40:43], v[112:115], a[24:27], v[40:43]
  ds_read_b128 v[108:111], v4 offset:1024
  buffer_load_dwordx4 a[64:67], v2, s[8:11], s36 offen offset:0 sc1
  v_mfma_f32_16x16x32_bf16 v[44:47], v[112:115], a[28:31], v[44:47]
  s_waitcnt lgkmcnt(4)
  buffer_load_dwordx4 a[68:71], v2, s[8:11], s37 offen offset:0 sc1
  v_mfma_f32_16x16x32_bf16 v[48:51], v[116:119], a[24:27], v[48:51]
  ds_read_b128 v[112:115], v4 offset:2048
  v_mfma_f32_16x16x32_bf16 v[52:55], v[116:119], a[28:31], v[52:55]
  s_waitcnt vmcnt(8)
  s_waitcnt lgkmcnt(4)
  v_mfma_f32_16x16x32_bf16 v[32:35], v[96:99], a[32:35], v[32:35]
  ds_read_b128 v[116:119], v4 offset:3072
  buffer_load_dwordx4 a[72:75], v2, s[8:11], s36 offen offset:1024 sc1
  v_mfma_f32_16x16x32_bf16 v[36:39], v[96:99], a[36:39], v[36:39]
  s_waitcnt lgkmcnt(4)
  v_mfma_f32_16x16x32_bf16 v[40:43], v[100:103], a[32:35], v[40:43]
  ds_read_b128 v[96:99], v4 offset:4096
  buffer_load_dwordx4 a[76:79], v2, s[8:11], s37 offen offset:1024 sc1
  v_mfma_f32_16x16x32_bf16 v[44:47], v[100:103], a[36:39], v[44:47]
  s_waitcnt lgkmcnt(4)
  v_add_f32 v208, v208, v210
  v_mfma_f32_16x16x32_bf16 v[48:51], v[104:107], a[32:35], v[48:51]
  ds_read_b128 v[100:103], v4 offset:5120
  buffer_load_dwordx4 a[80:83], v2, s[8:11], s36 offen offset:2048 sc1
  v_mfma_f32_16x16x32_bf16 v[52:55], v[104:107], a[36:39], v[52:55]
  s_waitcnt vmcnt(9)
  s_waitcnt lgkmcnt(4)
  v_mfma_f32_16x16x32_bf16 v[32:35], v[108:111], a[40:43], v[32:35]
  ds_read_b128 v[104:107], v4 offset:6144
  v_add_f32 v209, v209, v211
  v_mfma_f32_16x16x32_bf16 v[36:39], v[108:111], a[44:47], v[36:39]
  s_waitcnt lgkmcnt(4)
  v_add_f32 v212, v212, v214
  v_mfma_f32_16x16x32_bf16 v[40:43], v[112:115], a[40:43], v[40:43]
  ds_read_b128 v[108:111], v4 offset:7168
  buffer_load_dwordx4 a[84:87], v2, s[8:11], s37 offen offset:2048 sc1
  v_mfma_f32_16x16x32_bf16 v[44:47], v[112:115], a[44:47], v[44:47]
  s_waitcnt lgkmcnt(4)
  v_add_f32 v213, v213, v215
  v_mfma_f32_16x16x32_bf16 v[48:51], v[116:119], a[40:43], v[48:51]
  ds_read_b128 v[112:115], v4 offset:8192
  buffer_load_dwordx4 a[88:91], v2, s[8:11], s36 offen offset:3072 sc1
  v_mfma_f32_16x16x32_bf16 v[52:55], v[116:119], a[44:47], v[52:55]
  s_waitcnt vmcnt(9)
  s_waitcnt lgkmcnt(4)
  v_mfma_f32_16x16x32_bf16 v[32:35], v[96:99], a[48:51], v[32:35]
  ds_read_b128 v[116:119], v4 offset:9216
  buffer_load_dwordx4 a[92:95], v2, s[8:11], s37 offen offset:3072 sc1
  v_mfma_f32_16x16x32_bf16 v[36:39], v[96:99], a[52:55], v[36:39]
  s_waitcnt lgkmcnt(4)
  s_lshl_b32 s64, s3, 7
  v_mfma_f32_16x16x32_bf16 v[40:43], v[100:103], a[48:51], v[40:43]
  ds_read_b128 v[96:99], v4 offset:10240
  v_and_b32 v216, 31, v1
  v_mfma_f32_16x16x32_bf16 v[44:47], v[100:103], a[52:55], v[44:47]
  s_waitcnt lgkmcnt(4)
  v_permlane32_swap_b32 v208, v209
  v_mfma_f32_16x16x32_bf16 v[48:51], v[104:107], a[48:51], v[48:51]
  ds_read_b128 v[100:103], v4 offset:11264
  s_add_u32 s36, s36, 4096
  v_mfma_f32_16x16x32_bf16 v[52:55], v[104:107], a[52:55], v[52:55]
  s_waitcnt vmcnt(8)
  s_waitcnt lgkmcnt(4)
  v_mfma_f32_16x16x32_bf16 v[32:35], v[108:111], a[56:59], v[32:35]
  ds_read_b128 v[104:107], v4 offset:12288
  s_add_u32 s37, s37, 4096
  v_mfma_f32_16x16x32_bf16 v[36:39], v[108:111], a[60:63], v[36:39]
  s_waitcnt lgkmcnt(4)
  buffer_load_dwordx4 a[96:99], v2, s[8:11], s36 offen offset:0 sc1
  v_mfma_f32_16x16x32_bf16 v[40:43], v[112:115], a[56:59], v[40:43]
  ds_read_b128 v[108:111], v4 offset:13312
  buffer_load_dwordx4 a[100:103], v2, s[8:11], s37 offen offset:0 sc1
  v_mfma_f32_16x16x32_bf16 v[44:47], v[112:115], a[60:63], v[44:47]
  s_waitcnt lgkmcnt(4)
  v_permlane32_swap_b32 v212, v213
  v_mfma_f32_16x16x32_bf16 v[48:51], v[116:119], a[56:59], v[48:51]
  ds_read_b128 v[112:115], v4 offset:14336
  buffer_load_dwordx4 a[104:107], v2, s[8:11], s36 offen offset:1024 sc1
  v_mfma_f32_16x16x32_bf16 v[52:55], v[116:119], a[60:63], v[52:55]
  s_waitcnt vmcnt(9)
  s_waitcnt lgkmcnt(4)
  v_mfma_f32_16x16x32_bf16 v[32:35], v[96:99], a[64:67], v[32:35]
  ds_read_b128 v[116:119], v4 offset:15360
  buffer_load_dwordx4 a[108:111], v2, s[8:11], s37 offen offset:1024 sc1
  v_mfma_f32_16x16x32_bf16 v[36:39], v[96:99], a[68:71], v[36:39]
  s_waitcnt lgkmcnt(4)
  v_lshl_add_u32 v216, v216, 2, s64
  v_mfma_f32_16x16x32_bf16 v[40:43], v[100:103], a[64:67], v[40:43]
  ds_read_b128 v[96:99], v4 offset:16384
  buffer_load_dwordx4 a[112:115], v2, s[8:11], s36 offen offset:2048 sc1
  v_mfma_f32_16x16x32_bf16 v[44:47], v[100:103], a[68:71], v[44:47]
  s_waitcnt lgkmcnt(4)
  v_add_u32 v216, 156672, v216
  v_mfma_f32_16x16x32_bf16 v[48:51], v[104:107], a[64:67], v[48:51]
  ds_read_b128 v[100:103], v4 offset:17408
  v_add_f32 v208, v208, v209
  v_mfma_f32_16x16x32_bf16 v[52:55], v[104:107], a[68:71], v[52:55]
  s_waitcnt vmcnt(9)
  s_waitcnt lgkmcnt(4)
  v_mfma_f32_16x16x32_bf16 v[32:35], v[108:111], a[72:75], v[32:35]
  ds_read_b128 v[104:107], v4 offset:18432
  buffer_load_dwordx4 a[116:119], v2, s[8:11], s37 offen offset:2048 sc1
  v_mfma_f32_16x16x32_bf16 v[36:39], v[108:111], a[76:79], v[36:39]
  s_waitcnt lgkmcnt(4)
  v_add_f32 v212, v212, v213
  v_mfma_f32_16x16x32_bf16 v[40:43], v[112:115], a[72:75], v[40:43]
  ds_read_b128 v[108:111], v4 offset:19456
  buffer_load_dwordx4 a[120:123], v2, s[8:11], s36 offen offset:3072 sc1
  v_mfma_f32_16x16x32_bf16 v[44:47], v[112:115], a[76:79], v[44:47]
  s_waitcnt lgkmcnt(4)
  v_permlane16_swap_b32 v208, v212
  v_mfma_f32_16x16x32_bf16 v[48:51], v[116:119], a[72:75], v[48:51]
  ds_read_b128 v[112:115], v4 offset:20480
  buffer_load_dwordx4 a[124:127], v2, s[8:11], s37 offen offset:3072 sc1
  v_mfma_f32_16x16x32_bf16 v[52:55], v[116:119], a[76:79], v[52:55]
  s_waitcnt vmcnt(10)
  s_waitcnt lgkmcnt(4)
  v_mfma_f32_16x16x32_bf16 v[32:35], v[96:99], a[80:83], v[32:35]
  ds_read_b128 v[116:119], v4 offset:21504
  v_add_f32 v208, v208, v212
  v_mfma_f32_16x16x32_bf16 v[36:39], v[96:99], a[84:87], v[36:39]
  s_waitcnt lgkmcnt(4)
  v_mov_b32 v209, v208
  v_mfma_f32_16x16x32_bf16 v[40:43], v[100:103], a[80:83], v[40:43]
  ds_read_b128 v[96:99], v4 offset:22528
  s_add_u32 s36, s36, 4096
  v_mfma_f32_16x16x32_bf16 v[44:47], v[100:103], a[84:87], v[44:47]
  s_waitcnt lgkmcnt(4)
  s_add_u32 s37, s37, 4096
  v_mfma_f32_16x16x32_bf16 v[48:51], v[104:107], a[80:83], v[48:51]
  ds_read_b128 v[100:103], v4 offset:23552
  buffer_load_dwordx4 a[128:131], v2, s[8:11], s36 offen offset:0 sc1
  v_mfma_f32_16x16x32_bf16 v[52:55], v[104:107], a[84:87], v[52:55]
  s_waitcnt vmcnt(9)
  s_waitcnt lgkmcnt(4)
  v_mfma_f32_16x16x32_bf16 v[32:35], v[108:111], a[88:91], v[32:35]
  ds_read_b128 v[104:107], v4 offset:24576
  buffer_load_dwordx4 a[132:135], v2, s[8:11], s37 offen offset:0 sc1
  v_mfma_f32_16x16x32_bf16 v[36:39], v[108:111], a[92:95], v[36:39]
  s_waitcnt lgkmcnt(4)
  v_permlane32_swap_b32 v208, v209
  v_mfma_f32_16x16x32_bf16 v[40:43], v[112:115], a[88:91], v[40:43]
  ds_read_b128 v[108:111], v4 offset:25600
  buffer_load_dwordx4 a[136:139], v2, s[8:11], s36 offen offset:1024 sc1
  v_mfma_f32_16x16x32_bf16 v[44:47], v[112:115], a[92:95], v[44:47]
  s_waitcnt lgkmcnt(4)
  v_mul_f32 v208, 0x3acccccd, v208
  v_mfma_f32_16x16x32_bf16 v[48:51], v[116:119], a[88:91], v[48:51]
  ds_read_b128 v[112:115], v4 offset:26624
  buffer_load_dwordx4 a[140:143], v2, s[8:11], s37 offen offset:1024 sc1
  v_mfma_f32_16x16x32_bf16 v[52:55], v[116:119], a[92:95], v[52:55]
  s_waitcnt vmcnt(10)
  s_waitcnt lgkmcnt(4)
  v_mfma_f32_16x16x32_bf16 v[32:35], v[96:99], a[96:99], v[32:35]
  ds_read_b128 v[116:119], v4 offset:27648
  buffer_load_dwordx4 a[144:147], v2, s[8:11], s36 offen offset:2048 sc1
  v_mfma_f32_16x16x32_bf16 v[36:39], v[96:99], a[100:103], v[36:39]
  s_waitcnt lgkmcnt(4)
  v_mul_f32 v209, 0x3acccccd, v209
  v_mfma_f32_16x16x32_bf16 v[40:43], v[100:103], a[96:99], v[40:43]
  ds_read_b128 v[96:99], v4 offset:28672
  v_fma_f32 v209, -v208, v208, v209
  v_mfma_f32_16x16x32_bf16 v[44:47], v[100:103], a[100:103], v[44:47]
  s_waitcnt lgkmcnt(4)
  v_max_f32 v209, 0, v209
  v_mfma_f32_16x16x32_bf16 v[48:51], v[104:107], a[96:99], v[48:51]
  ds_read_b128 v[100:103], v4 offset:29696
  buffer_load_dwordx4 a[148:151], v2, s[8:11], s37 offen offset:2048 sc1
  v_mfma_f32_16x16x32_bf16 v[52:55], v[104:107], a[100:103], v[52:55]
  s_waitcnt vmcnt(10)
  s_waitcnt lgkmcnt(4)
  v_mfma_f32_16x16x32_bf16 v[32:35], v[108:111], a[104:107], v[32:35]
  ds_read_b128 v[104:107], v4 offset:30720
  buffer_load_dwordx4 a[152:155], v2, s[8:11], s36 offen offset:3072 sc1
  v_mfma_f32_16x16x32_bf16 v[36:39], v[108:111], a[108:111], v[36:39]
  s_waitcnt lgkmcnt(4)
  v_add_f32 v209, 0x3727c5ac, v209
  v_mfma_f32_16x16x32_bf16 v[40:43], v[112:115], a[104:107], v[40:43]
  ds_read_b128 v[108:111], v4 offset:31744
  buffer_load_dwordx4 a[156:159], v2, s[8:11], s37 offen offset:3072 sc1
  v_mfma_f32_16x16x32_bf16 v[44:47], v[112:115], a[108:111], v[44:47]
  s_waitcnt lgkmcnt(4)
  v_rsq_f32 v209, v209
  v_mfma_f32_16x16x32_bf16 v[48:51], v[116:119], a[104:107], v[48:51]
  ds_read_b128 v[112:115], v4 offset:32768
  v_mul_f32 v208, v208, v209
  v_mfma_f32_16x16x32_bf16 v[52:55], v[116:119], a[108:111], v[52:55]
  s_waitcnt vmcnt(10)
  s_waitcnt lgkmcnt(4)
  v_mfma_f32_16x16x32_bf16 v[32:35], v[96:99], a[112:115], v[32:35]
  ds_read_b128 v[116:119], v4 offset:33792
  v_sub_f32 v208, 0, v208
  v_mfma_f32_16x16x32_bf16 v[36:39], v[96:99], a[116:119], v[36:39]
  s_waitcnt lgkmcnt(4)
  ds_write_b32 v216, v209
  v_mfma_f32_16x16x32_bf16 v[40:43], v[100:103], a[112:115], v[40:43]
  ds_read_b128 v[96:99], v4 offset:36864
  ds_write_b32 v216, v208 offset:512
  v_mfma_f32_16x16x32_bf16 v[44:47], v[100:103], a[116:119], v[44:47]
  s_waitcnt lgkmcnt(6)
  s_lshl_b32 s64, s3, 7
  v_mfma_f32_16x16x32_bf16 v[48:51], v[104:107], a[112:115], v[48:51]
  ds_read_b128 v[100:103], v4 offset:37888
  v_lshl_add_u32 v216, v9, 4, s64
  v_mfma_f32_16x16x32_bf16 v[52:55], v[104:107], a[116:119], v[52:55]
  s_waitcnt vmcnt(8)
  s_waitcnt lgkmcnt(6)
  v_mfma_f32_16x16x32_bf16 v[32:35], v[108:111], a[120:123], v[32:35]
  ds_read_b128 v[104:107], v4 offset:38912
  v_add_u32 v216, 156672, v216
  v_mfma_f32_16x16x32_bf16 v[36:39], v[108:111], a[124:127], v[36:39]
  s_waitcnt lgkmcnt(6)
  v_lshl_add_u32 v217, v10, 2, s64
  v_mfma_f32_16x16x32_bf16 v[40:43], v[112:115], a[120:123], v[40:43]
  ds_read_b128 v[108:111], v4 offset:39936
  v_add_u32 v217, 156672, v217
  v_mfma_f32_16x16x32_bf16 v[44:47], v[112:115], a[124:127], v[44:47]
  s_waitcnt lgkmcnt(6)
  ds_read_b128 v[120:123], v216 offset:0
  v_mfma_f32_16x16x32_bf16 v[48:51], v[116:119], a[120:123], v[48:51]
  ds_read_b128 v[112:115], v4 offset:40960
  ds_read_b128 v[128:131], v216 offset:512
  v_mfma_f32_16x16x32_bf16 v[52:55], v[116:119], a[124:127], v[52:55]
  s_waitcnt vmcnt(6)
  s_waitcnt lgkmcnt(7)
  v_mfma_f32_16x16x32_bf16 v[32:35], v[96:99], a[128:131], v[32:35]
  ds_read_b128 v[116:119], v4 offset:41984
  ds_read_b32 v136, v217 offset:0
  v_mfma_f32_16x16x32_bf16 v[36:39], v[96:99], a[132:135], v[36:39]
  s_waitcnt lgkmcnt(7)
  ds_read_b32 v138, v217 offset:512
  v_mfma_f32_16x16x32_bf16 v[40:43], v[100:103], a[128:131], v[40:43]
  ds_read_b128 v[96:99], v4 offset:43008
  ds_read_b128 v[124:127], v216 offset:64
  v_mfma_f32_16x16x32_bf16 v[44:47], v[100:103], a[132:135], v[44:47]
  s_waitcnt lgkmcnt(9)
  v_mfma_f32_16x16x32_bf16 v[48:51], v[104:107], a[128:131], v[48:51]
  ds_read_b128 v[100:103], v4 offset:44032
  ds_read_b128 v[132:135], v216 offset:576
  v_mfma_f32_16x16x32_bf16 v[52:55], v[104:107], a[132:135], v[52:55]
  s_waitcnt vmcnt(4)
  s_waitcnt lgkmcnt(10)
  v_mfma_f32_16x16x32_bf16 v[32:35], v[108:111], a[136:139], v[32:35]
  ds_read_b128 v[104:107], v4 offset:45056
  ds_read_b32 v137, v217 offset:64
  v_mfma_f32_16x16x32_bf16 v[36:39], v[108:111], a[140:143], v[36:39]
  s_waitcnt lgkmcnt(10)
  v_mfma_f32_16x16x32_bf16 v[40:43], v[112:115], a[136:139], v[40:43]
  ds_read_b128 v[108:111], v4 offset:46080
  ds_read_b32 v139, v217 offset:576
  v_mfma_f32_16x16x32_bf16 v[44:47], v[112:115], a[140:143], v[44:47]
  s_waitcnt lgkmcnt(10)
  v_mfma_f32_16x16x32_bf16 v[48:51], v[116:119], a[136:139], v[48:51]
  ds_read_b128 v[112:115], v4 offset:47104
  v_lshlrev_b32 v199, 4, v9
  v_mfma_f32_16x16x32_bf16 v[52:55], v[116:119], a[140:143], v[52:55]
  s_waitcnt vmcnt(2)
  s_waitcnt lgkmcnt(8)
  v_mfma_f32_16x16x32_bf16 v[32:35], v[96:99], a[144:147], v[32:35]
  ds_read_b128 v[116:119], v4 offset:48128
  v_add_u32 v199, 156160, v199
  v_mfma_f32_16x16x32_bf16 v[36:39], v[96:99], a[148:151], v[36:39]
  s_waitcnt lgkmcnt(7)
  v_mfma_f32_16x16x32_bf16 v[40:43], v[100:103], a[144:147], v[40:43]
  ds_read_b128 v[144:147], v199 offset:0
  v_mfma_f32_16x16x32_bf16 v[44:47], v[100:103], a[148:151], v[44:47]
  s_waitcnt lgkmcnt(6)
  v_mfma_f32_16x16x32_bf16 v[48:51], v[104:107], a[144:147], v[48:51]
  ds_read_b128 v[148:151], v199 offset:64
  v_mfma_f32_16x16x32_bf16 v[52:55], v[104:107], a[148:151], v[52:55]
  s_waitcnt vmcnt(0)
  s_waitcnt lgkmcnt(5)
  v_mfma_f32_16x16x32_bf16 v[32:35], v[108:111], a[152:155], v[32:35]
  ds_read_b128 v[152:155], v199 offset:128
  v_mfma_f32_16x16x32_bf16 v[36:39], v[108:111], a[156:159], v[36:39]
  s_waitcnt lgkmcnt(4)
  v_mfma_f32_16x16x32_bf16 v[40:43], v[112:115], a[152:155], v[40:43]
  v_mfma_f32_16x16x32_bf16 v[44:47], v[112:115], a[156:159], v[44:47]
  s_waitcnt lgkmcnt(3)
  v_mfma_f32_16x16x32_bf16 v[48:51], v[116:119], a[152:155], v[48:51]
  v_mfma_f32_16x16x32_bf16 v[52:55], v[116:119], a[156:159], v[52:55]
  v_mov_b32 v165, 0x3ea52b5c
  v_cndmask_b32_e64 v164, 1.0, v165, s[52:53]
  s_mul_i32 s60, s24, 7340032
  s_lshl_b32 s61, s21, 4
  s_add_u32 s61, s61, s20
  s_mul_i32 s62, s61, 28672
  s_add_u32 s60, s60, s62
  s_add_u32 s68, s60, 28622848
  s_lshl_b32 s62, s24, 8
  s_add_u32 s61, s61, s62
  s_lshl_b32 s61, s61, 9
  s_lshl_b32 s62, s3, 7
  s_add_u32 s61, s61, s62
  s_add_u32 s69, s61, 43827200
  s_lshl_b32 s61, s3, 12
  s_add_u32 s60, s68, s61
  s_waitcnt lgkmcnt(0)
  v_mul_f32 v160, v136, v164
  v_mul_f32 v162, v138, v164
  v_mul_f32 v161, v137, v164
  v_mul_f32 v163, v139, v164
  v_pk_mul_f32 v[200:201], v[144:145], v[138:139] op_sel:[0,0] op_sel_hi:[1,0]
  v_pk_mul_f32 v[202:203], v[146:147], v[138:139] op_sel:[0,0] op_sel_hi:[1,0]
  v_pk_fma_f32 v[32:33], v[32:33], v[136:137], v[200:201] op_sel:[0,0,0] op_sel_hi:[1,0,1]
  v_pk_fma_f32 v[34:35], v[34:35], v[136:137], v[202:203] op_sel:[0,0,0] op_sel_hi:[1,0,1]
  v_pk_mul_f32 v[200:201], v[148:149], v[138:139] op_sel:[0,0] op_sel_hi:[1,0]
  v_pk_mul_f32 v[202:203], v[150:151], v[138:139] op_sel:[0,0] op_sel_hi:[1,0]
  v_pk_fma_f32 v[40:41], v[40:41], v[136:137], v[200:201] op_sel:[0,0,0] op_sel_hi:[1,0,1]
  v_pk_fma_f32 v[42:43], v[42:43], v[136:137], v[202:203] op_sel:[0,0,0] op_sel_hi:[1,0,1]
  v_pk_mul_f32 v[200:201], v[152:153], v[162:163] op_sel:[0,0] op_sel_hi:[1,0]
  v_pk_mul_f32 v[202:203], v[154:155], v[162:163] op_sel:[0,0] op_sel_hi:[1,0]
  v_pk_fma_f32 v[48:49], v[48:49], v[160:161], v[200:201] op_sel:[0,0,0] op_sel_hi:[1,0,1]
  v_pk_fma_f32 v[50:51], v[50:51], v[160:161], v[202:203] op_sel:[0,0,0] op_sel_hi:[1,0,1]
  v_cvt_pk_bf16_f32 v168, v32, v33
  v_cvt_pk_bf16_f32 v169, v34, v35
  v_cvt_pk_bf16_f32 v172, v40, v41
  v_cvt_pk_bf16_f32 v173, v42, v43
  v_cvt_pk_bf16_f32 v170, v48, v49
  v_cvt_pk_bf16_f32 v171, v50, v51
  v_mov_b32 v184, 0
  v_mov_b32 v185, 0
  s_nop 0
  v_permlane32_swap_b32 v170, v184
  v_permlane32_swap_b32 v171, v185
  v_mov_b32 v174, v170
  v_mov_b32 v175, v171
  buffer_store_dwordx4 v[168:171], v2, s[8:11], s60 offen offset:0 sc1
  buffer_store_dwordx4 v[172:175], v2, s[8:11], s60 offen offset:1024 sc1
  v_pk_mul_f32 v[200:201], v[144:145], v[138:139] op_sel:[0,1] op_sel_hi:[1,1]
  v_pk_mul_f32 v[202:203], v[146:147], v[138:139] op_sel:[0,1] op_sel_hi:[1,1]
  v_pk_fma_f32 v[36:37], v[36:37], v[136:137], v[200:201] op_sel:[0,1,0] op_sel_hi:[1,1,1]
  v_pk_fma_f32 v[38:39], v[38:39], v[136:137], v[202:203] op_sel:[0,1,0] op_sel_hi:[1,1,1]
  v_pk_mul_f32 v[200:201], v[148:149], v[138:139] op_sel:[0,1] op_sel_hi:[1,1]
  v_pk_mul_f32 v[202:203], v[150:151], v[138:139] op_sel:[0,1] op_sel_hi:[1,1]
  v_pk_fma_f32 v[44:45], v[44:45], v[136:137], v[200:201] op_sel:[0,1,0] op_sel_hi:[1,1,1]
  v_pk_fma_f32 v[46:47], v[46:47], v[136:137], v[202:203] op_sel:[0,1,0] op_sel_hi:[1,1,1]
  v_pk_mul_f32 v[200:201], v[152:153], v[162:163] op_sel:[0,1] op_sel_hi:[1,1]
  v_pk_mul_f32 v[202:203], v[154:155], v[162:163] op_sel:[0,1] op_sel_hi:[1,1]
  v_pk_fma_f32 v[52:53], v[52:53], v[160:161], v[200:201] op_sel:[0,1,0] op_sel_hi:[1,1,1]
  v_pk_fma_f32 v[54:55], v[54:55], v[160:161], v[202:203] op_sel:[0,1,0] op_sel_hi:[1,1,1]
  v_cvt_pk_bf16_f32 v176, v36, v37
  v_cvt_pk_bf16_f32 v177, v38, v39
  v_cvt_pk_bf16_f32 v180, v44, v45
  v_cvt_pk_bf16_f32 v181, v46, v47
  v_cvt_pk_bf16_f32 v178, v52, v53
  v_cvt_pk_bf16_f32 v179, v54, v55
  v_mov_b32 v186, 0
  v_mov_b32 v187, 0
  s_nop 0
  v_permlane32_swap_b32 v178, v186
  v_permlane32_swap_b32 v179, v187
  v_mov_b32 v182, v178
  v_mov_b32 v183, v179
  buffer_store_dwordx4 v[176:179], v2, s[8:11], s60 offen offset:2048 sc1
  buffer_store_dwordx4 v[180:183], v2, s[8:11], s60 offen offset:3072 sc1
  s_barrier
  s_add_u32 s61, s61, 83968
  v_add_u32 v140, s61, v2
  ds_write_b128 v140, v[168:171] offset:0
  ds_write_b128 v140, v[172:175] offset:1024
  ds_write_b128 v140, v[176:179] offset:2048
  ds_write_b128 v140, v[180:183] offset:3072
  v_lshlrev_b32 v218, 2, v10
  v_mov_b32 v224, 1
  v_mov_b32 v225, 1
  v_mov_b32 v226, 1
  v_mov_b32 v227, 1
  s_min_u32 s60, s20, 1
  s_min_u32 s61, s20, 2
  s_lshl_b32 s60, s60, 9
  s_lshl_b32 s61, s61, 9
  s_sub_u32 s70, s69, s60
  s_sub_u32 s71, s69, s61
  v_mov_b32 v245, s70
  v_mov_b32 v221, s71
  v_and_b32 v222, 1, v9
  v_cmp_eq_u32 s[56:57], 1, v222
  s_nop 1
  v_cndmask_b32_e64 v245, v245, v221, s[56:57]
  ds_read_b128 v[96:99], v3 offset:0
  ds_read_b128 v[100:103], v3 offset:1024
  ds_read_b128 v[104:107], v6 offset:2048
  ds_read_b128 v[108:111], v3 offset:2560
  ds_read_b128 v[112:115], v3 offset:3584
  s_waitcnt lgkmcnt(4)
  v_mfma_f32_16x16x32_bf16 v[32:35], a[0:3], v[96:99], 0
  ds_read_b128 v[116:119], v6 offset:4608
  v_mfma_f32_16x16x32_bf16 v[36:39], a[4:7], v[96:99], 0
  s_waitcnt lgkmcnt(4)
  v_mfma_f32_16x16x32_bf16 v[40:43], a[0:3], v[100:103], 0
  ds_read_b128 v[96:99], v3 offset:5120
  v_mfma_f32_16x16x32_bf16 v[44:47], a[4:7], v[100:103], 0
  s_waitcnt lgkmcnt(4)
  v_mfma_f32_16x16x32_bf16 v[48:51], a[0:3], v[104:107], 0
  ds_read_b128 v[100:103], v3 offset:6144
  v_lshlrev_b32 v198, 2, v10
  v_mfma_f32_16x16x32_bf16 v[52:55], a[4:7], v[104:107], 0
  s_waitcnt lgkmcnt(4)
  v_mfma_f32_16x16x32_bf16 v[32:35], a[8:11], v[108:111], v[32:35]
  ds_read_b128 v[104:107], v6 offset:7168
  v_add_u32 v198, 156160, v198
  v_mfma_f32_16x16x32_bf16 v[36:39], a[12:15], v[108:111], v[36:39]
  s_waitcnt lgkmcnt(4)
  v_mfma_f32_16x16x32_bf16 v[40:43], a[8:11], v[112:115], v[40:43]
  ds_read_b128 v[108:111], v3 offset:7680
  ds_read_b32 v156, v198 offset:192
  v_mfma_f32_16x16x32_bf16 v[44:47], a[12:15], v[112:115], v[44:47]
  s_waitcnt lgkmcnt(5)
  v_mfma_f32_16x16x32_bf16 v[48:51], a[8:11], v[116:119], v[48:51]
  ds_read_b128 v[112:115], v3 offset:8704
  ds_read_b32 v157, v198 offset:256
  v_mfma_f32_16x16x32_bf16 v[52:55], a[12:15], v[116:119], v[52:55]
  s_waitcnt lgkmcnt(6)
  v_mfma_f32_16x16x32_bf16 v[32:35], a[16:19], v[96:99], v[32:35]
  ds_read_b128 v[116:119], v6 offset:9728
  ds_read_b32 v158, v198 offset:320
  v_mfma_f32_16x16x32_bf16 v[36:39], a[20:23], v[96:99], v[36:39]
  s_waitcnt lgkmcnt(7)
  v_mfma_f32_16x16x32_bf16 v[40:43], a[16:19], v[100:103], v[40:43]
  ds_read_b128 v[96:99], v3 offset:10240
  v_mfma_f32_16x16x32_bf16 v[44:47], a[20:23], v[100:103], v[44:47]
  s_waitcnt lgkmcnt(7)
  v_mfma_f32_16x16x32_bf16 v[48:51], a[16:19], v[104:107], v[48:51]
  ds_read_b128 v[100:103], v3 offset:11264
  v_mfma_f32_16x16x32_bf16 v[52:55], a[20:23], v[104:107], v[52:55]
  s_waitcnt lgkmcnt(7)
  v_mfma_f32_16x16x32_bf16 v[32:35], a[24:27], v[108:111], v[32:35]
  ds_read_b128 v[104:107], v6 offset:12288
  v_mfma_f32_16x16x32_bf16 v[36:39], a[28:31], v[108:111], v[36:39]
  s_waitcnt lgkmcnt(6)
  v_mfma_f32_16x16x32_bf16 v[40:43], a[24:27], v[112:115], v[40:43]
  ds_read_b128 v[108:111], v3 offset:12800
  s_mul_i32 s35, s3, 10
  v_mfma_f32_16x16x32_bf16 v[44:47], a[28:31], v[112:115], v[44:47]
  s_waitcnt lgkmcnt(5)
  s_min_u32 s35, s35, 30
  v_mfma_f32_16x16x32_bf16 v[48:51], a[24:27], v[116:119], v[48:51]
  ds_read_b128 v[112:115], v3 offset:13824
  s_lshl_b32 s35, s35, 10
  v_mfma_f32_16x16x32_bf16 v[52:55], a[28:31], v[116:119], v[52:55]
  s_waitcnt lgkmcnt(4)
  s_add_u32 s34, s31, s35
  v_mfma_f32_16x16x32_bf16 v[32:35], a[32:35], v[96:99], v[32:35]
  ds_read_b128 v[116:119], v6 offset:14848
  s_add_u32 s34, s34, 112640
  v_mfma_f32_16x16x32_bf16 v[36:39], a[36:39], v[96:99], v[36:39]
  s_waitcnt lgkmcnt(4)
  s_add_u32 s35, s35, 114688
  v_mfma_f32_16x16x32_bf16 v[40:43], a[32:35], v[100:103], v[40:43]
  ds_read_b128 v[96:99], v3 offset:15360
  s_mov_b32 m0, s35
  v_mfma_f32_16x16x32_bf16 v[44:47], a[36:39], v[100:103], v[44:47]
  s_waitcnt lgkmcnt(4)
  buffer_load_dwordx4 v2, s[8:11], s34 offen offset:0 lds
  v_mfma_f32_16x16x32_bf16 v[48:51], a[32:35], v[104:107], v[48:51]
  ds_read_b128 v[100:103], v3 offset:16384
  buffer_load_dwordx4 v2, s[8:11], s34 offen offset:1024 lds
  v_mfma_f32_16x16x32_bf16 v[52:55], a[36:39], v[104:107], v[52:55]
  s_waitcnt lgkmcnt(4)
  buffer_load_dwordx4 v2, s[8:11], s34 offen offset:2048 lds
  v_mfma_f32_16x16x32_bf16 v[32:35], a[40:43], v[108:111], v[32:35]
  ds_read_b128 v[104:107], v6 offset:17408
  v_mfma_f32_16x16x32_bf16 v[36:39], a[44:47], v[108:111], v[36:39]
  s_waitcnt lgkmcnt(4)
  v_mfma_f32_16x16x32_bf16 v[40:43], a[40:43], v[112:115], v[40:43]
  ds_read_b128 v[108:111], v3 offset:17920
  buffer_load_dwordx4 v2, s[8:11], s34 offen offset:3072 lds
  v_mfma_f32_16x16x32_bf16 v[44:47], a[44:47], v[112:115], v[44:47]
  s_waitcnt lgkmcnt(4)
  v_mfma_f32_16x16x32_bf16 v[48:51], a[40:43], v[116:119], v[48:51]
  ds_read_b128 v[112:115], v3 offset:18944
  v_mfma_f32_16x16x32_bf16 v[52:55], a[44:47], v[116:119], v[52:55]
  s_waitcnt lgkmcnt(4)
  v_mfma_f32_16x16x32_bf16 v[32:35], a[48:51], v[96:99], v[32:35]
  ds_read_b128 v[116:119], v6 offset:19968
  s_add_u32 s35, s35, 4096
  v_mfma_f32_16x16x32_bf16 v[36:39], a[52:55], v[96:99], v[36:39]
  s_waitcnt lgkmcnt(4)
  s_add_u32 s34, s34, 4096
  v_mfma_f32_16x16x32_bf16 v[40:43], a[48:51], v[100:103], v[40:43]
  ds_read_b128 v[96:99], v3 offset:20480
  s_mov_b32 m0, s35
  v_mfma_f32_16x16x32_bf16 v[44:47], a[52:55], v[100:103], v[44:47]
  s_waitcnt lgkmcnt(4)
  buffer_load_dwordx4 v2, s[8:11], s34 offen offset:0 lds
  v_mfma_f32_16x16x32_bf16 v[48:51], a[48:51], v[104:107], v[48:51]
  ds_read_b128 v[100:103], v3 offset:21504
  buffer_load_dwordx4 v2, s[8:11], s34 offen offset:1024 lds
  v_mfma_f32_16x16x32_bf16 v[52:55], a[52:55], v[104:107], v[52:55]
  s_waitcnt lgkmcnt(4)
  v_mfma_f32_16x16x32_bf16 v[32:35], a[56:59], v[108:111], v[32:35]
  ds_read_b128 v[104:107], v6 offset:22528
  v_mfma_f32_16x16x32_bf16 v[36:39], a[60:63], v[108:111], v[36:39]
  s_waitcnt lgkmcnt(4)
  v_mfma_f32_16x16x32_bf16 v[40:43], a[56:59], v[112:115], v[40:43]
  ds_read_b128 v[108:111], v3 offset:23040
  buffer_load_dwordx4 v2, s[8:11], s34 offen offset:2048 lds
  v_mfma_f32_16x16x32_bf16 v[44:47], a[60:63], v[112:115], v[44:47]
  s_waitcnt lgkmcnt(4)
  s_waitcnt vmcnt(7)
  s_mov_b64 exec, 1
  buffer_store_dwordx4 v[224:227], v218, s[8:11], s69 offen offset:0 sc1
  s_mov_b64 exec, -1
  v_mfma_f32_16x16x32_bf16 v[48:51], a[56:59], v[116:119], v[48:51]
  ds_read_b128 v[112:115], v3 offset:24064
  v_mfma_f32_16x16x32_bf16 v[52:55], a[60:63], v[116:119], v[52:55]
  s_waitcnt lgkmcnt(4)
  v_mfma_f32_16x16x32_bf16 v[32:35], a[64:67], v[96:99], v[32:35]
  ds_read_b128 v[116:119], v6 offset:25088
  buffer_load_dwordx4 v2, s[8:11], s34 offen offset:3072 lds
  v_mfma_f32_16x16x32_bf16 v[36:39], a[68:71], v[96:99], v[36:39]
  s_waitcnt lgkmcnt(4)
  v_mfma_f32_16x16x32_bf16 v[40:43], a[64:67], v[100:103], v[40:43]
  ds_read_b128 v[96:99], v3 offset:25600
  v_mfma_f32_16x16x32_bf16 v[44:47], a[68:71], v[100:103], v[44:47]
  s_waitcnt lgkmcnt(4)
  v_mfma_f32_16x16x32_bf16 v[48:51], a[64:67], v[104:107], v[48:51]
  ds_read_b128 v[100:103], v3 offset:26624
  s_add_u32 s35, s35, 4096
  v_mfma_f32_16x16x32_bf16 v[52:55], a[68:71], v[104:107], v[52:55]
  s_waitcnt lgkmcnt(4)
  s_add_u32 s34, s34, 4096
  v_mfma_f32_16x16x32_bf16 v[32:35], a[72:75], v[108:111], v[32:35]
  ds_read_b128 v[104:107], v6 offset:27648
  s_mov_b32 m0, s35
  v_mfma_f32_16x16x32_bf16 v[36:39], a[76:79], v[108:111], v[36:39]
  s_waitcnt lgkmcnt(4)
  buffer_load_dwordx4 v2, s[8:11], s34 offen offset:0 lds
  v_mfma_f32_16x16x32_bf16 v[40:43], a[72:75], v[112:115], v[40:43]
  ds_read_b128 v[108:111], v3 offset:28160
  buffer_load_dwordx4 v2, s[8:11], s34 offen offset:1024 lds
  v_mfma_f32_16x16x32_bf16 v[44:47], a[76:79], v[112:115], v[44:47]
  s_waitcnt lgkmcnt(4)
  v_mfma_f32_16x16x32_bf16 v[48:51], a[72:75], v[116:119], v[48:51]
  ds_read_b128 v[112:115], v3 offset:29184
  v_mfma_f32_16x16x32_bf16 v[52:55], a[76:79], v[116:119], v[52:55]
  s_waitcnt lgkmcnt(4)
  v_mfma_f32_16x16x32_bf16 v[32:35], a[80:83], v[96:99], v[32:35]
  ds_read_b128 v[116:119], v6 offset:30208
  v_mfma_f32_16x16x32_bf16 v[36:39], a[84:87], v[96:99], v[36:39]
  s_waitcnt lgkmcnt(4)
  v_mfma_f32_16x16x32_bf16 v[40:43], a[80:83], v[100:103], v[40:43]
  ds_read_b128 v[96:99], v3 offset:30720
  v_mfma_f32_16x16x32_bf16 v[44:47], a[84:87], v[100:103], v[44:47]
  s_waitcnt lgkmcnt(4)
  v_mfma_f32_16x16x32_bf16 v[48:51], a[80:83], v[104:107], v[48:51]
  ds_read_b128 v[100:103], v3 offset:31744
  v_mfma_f32_16x16x32_bf16 v[52:55], a[84:87], v[104:107], v[52:55]
  s_waitcnt lgkmcnt(4)
  v_mfma_f32_16x16x32_bf16 v[32:35], a[88:91], v[108:111], v[32:35]
  ds_read_b128 v[104:107], v6 offset:32768
  v_mfma_f32_16x16x32_bf16 v[36:39], a[92:95], v[108:111], v[36:39]
  s_waitcnt lgkmcnt(4)
  v_mfma_f32_16x16x32_bf16 v[40:43], a[88:91], v[112:115], v[40:43]
  ds_read_b128 v[108:111], v3 offset:33280
  v_mfma_f32_16x16x32_bf16 v[44:47], a[92:95], v[112:115], v[44:47]
  s_waitcnt lgkmcnt(4)
  v_mfma_f32_16x16x32_bf16 v[48:51], a[88:91], v[116:119], v[48:51]
  ds_read_b128 v[112:115], v3 offset:34304
  v_mfma_f32_16x16x32_bf16 v[52:55], a[92:95], v[116:119], v[52:55]
  s_waitcnt lgkmcnt(4)
  v_mfma_f32_16x16x32_bf16 v[32:35], a[96:99], v[96:99], v[32:35]
  ds_read_b128 v[116:119], v6 offset:35328
  v_mfma_f32_16x16x32_bf16 v[36:39], a[100:103], v[96:99], v[36:39]
  s_waitcnt lgkmcnt(4)
  v_mfma_f32_16x16x32_bf16 v[40:43], a[96:99], v[100:103], v[40:43]
  ds_read_b128 v[96:99], v3 offset:35840
  v_mfma_f32_16x16x32_bf16 v[44:47], a[100:103], v[100:103], v[44:47]
  s_waitcnt lgkmcnt(4)
  v_mfma_f32_16x16x32_bf16 v[48:51], a[96:99], v[104:107], v[48:51]
  ds_read_b128 v[100:103], v3 offset:36864
  v_mfma_f32_16x16x32_bf16 v[52:55], a[100:103], v[104:107], v[52:55]
  s_waitcnt lgkmcnt(4)
  v_mfma_f32_16x16x32_bf16 v[32:35], a[104:107], v[108:111], v[32:35]
  ds_read_b128 v[104:107], v6 offset:37888
  v_mfma_f32_16x16x32_bf16 v[36:39], a[108:111], v[108:111], v[36:39]
  s_waitcnt lgkmcnt(4)
  v_mfma_f32_16x16x32_bf16 v[40:43], a[104:107], v[112:115], v[40:43]
  ds_read_b128 v[108:111], v3 offset:38400
  v_mfma_f32_16x16x32_bf16 v[44:47], a[108:111], v[112:115], v[44:47]
  s_waitcnt lgkmcnt(4)
  v_mfma_f32_16x16x32_bf16 v[48:51], a[104:107], v[116:119], v[48:51]
  ds_read_b128 v[112:115], v3 offset:39424
  v_mfma_f32_16x16x32_bf16 v[52:55], a[108:111], v[116:119], v[52:55]
  s_waitcnt lgkmcnt(4)
  v_mfma_f32_16x16x32_bf16 v[32:35], a[112:115], v[96:99], v[32:35]
  ds_read_b128 v[116:119], v6 offset:40448
  v_mfma_f32_16x16x32_bf16 v[36:39], a[116:119], v[96:99], v[36:39]
  s_waitcnt lgkmcnt(4)
  v_mfma_f32_16x16x32_bf16 v[40:43], a[112:115], v[100:103], v[40:43]
  ds_read_b128 v[96:99], v3 offset:40960
  v_mfma_f32_16x16x32_bf16 v[44:47], a[116:119], v[100:103], v[44:47]
  s_waitcnt lgkmcnt(4)
  v_mfma_f32_16x16x32_bf16 v[48:51], a[112:115], v[104:107], v[48:51]
  ds_read_b128 v[100:103], v3 offset:41984
  v_mfma_f32_16x16x32_bf16 v[52:55], a[116:119], v[104:107], v[52:55]
  s_waitcnt lgkmcnt(4)
  v_mfma_f32_16x16x32_bf16 v[32:35], a[120:123], v[108:111], v[32:35]
  ds_read_b128 v[104:107], v6 offset:43008
  v_mfma_f32_16x16x32_bf16 v[36:39], a[124:127], v[108:111], v[36:39]
  s_waitcnt lgkmcnt(4)
  v_mfma_f32_16x16x32_bf16 v[40:43], a[120:123], v[112:115], v[40:43]
  ds_read_b128 v[108:111], v3 offset:43520
  v_mfma_f32_16x16x32_bf16 v[44:47], a[124:127], v[112:115], v[44:47]
  s_waitcnt lgkmcnt(4)
  v_mfma_f32_16x16x32_bf16 v[48:51], a[120:123], v[116:119], v[48:51]
  ds_read_b128 v[112:115], v3 offset:44544
  v_mfma_f32_16x16x32_bf16 v[52:55], a[124:127], v[116:119], v[52:55]
  s_waitcnt lgkmcnt(4)
  v_mfma_f32_16x16x32_bf16 v[32:35], a[128:131], v[96:99], v[32:35]
  ds_read_b128 v[116:119], v6 offset:45568
  v_mfma_f32_16x16x32_bf16 v[36:39], a[132:135], v[96:99], v[36:39]
  s_waitcnt lgkmcnt(4)
  v_mfma_f32_16x16x32_bf16 v[40:43], a[128:131], v[100:103], v[40:43]
  ds_read_b128 v[96:99], v3 offset:46080
  v_mfma_f32_16x16x32_bf16 v[44:47], a[132:135], v[100:103], v[44:47]
  s_waitcnt lgkmcnt(4)
  v_mfma_f32_16x16x32_bf16 v[48:51], a[128:131], v[104:107], v[48:51]
  ds_read_b128 v[100:103], v3 offset:47104
  buffer_load_dword v250, v245, s[8:11], 0 offen offset:0 sc1
  v_mfma_f32_16x16x32_bf16 v[52:55], a[132:135], v[104:107], v[52:55]
  s_waitcnt lgkmcnt(4)
  v_mfma_f32_16x16x32_bf16 v[32:35], a[136:139], v[108:111], v[32:35]
  ds_read_b128 v[104:107], v6 offset:48128
  v_mfma_f32_16x16x32_bf16 v[36:39], a[140:143], v[108:111], v[36:39]
  s_waitcnt lgkmcnt(4)
  v_mfma_f32_16x16x32_bf16 v[40:43], a[136:139], v[112:115], v[40:43]
  ds_read_b128 v[108:111], v3 offset:48640
  v_mfma_f32_16x16x32_bf16 v[44:47], a[140:143], v[112:115], v[44:47]
  s_waitcnt lgkmcnt(4)
  v_mfma_f32_16x16x32_bf16 v[48:51], a[136:139], v[116:119], v[48:51]
  ds_read_b128 v[112:115], v3 offset:49664
  v_mfma_f32_16x16x32_bf16 v[52:55], a[140:143], v[116:119], v[52:55]
  s_waitcnt lgkmcnt(4)
  v_mfma_f32_16x16x32_bf16 v[32:35], a[144:147], v[96:99], v[32:35]
  ds_read_b128 v[116:119], v6 offset:50688
  v_mfma_f32_16x16x32_bf16 v[36:39], a[148:151], v[96:99], v[36:39]
  s_waitcnt lgkmcnt(4)
  v_mfma_f32_16x16x32_bf16 v[40:43], a[144:147], v[100:103], v[40:43]
  v_mfma_f32_16x16x32_bf16 v[44:47], a[148:151], v[100:103], v[44:47]
  s_waitcnt lgkmcnt(3)
  v_mfma_f32_16x16x32_bf16 v[48:51], a[144:147], v[104:107], v[48:51]
  v_mfma_f32_16x16x32_bf16 v[52:55], a[148:151], v[104:107], v[52:55]
  s_waitcnt lgkmcnt(2)
  v_mfma_f32_16x16x32_bf16 v[32:35], a[152:155], v[108:111], v[32:35]
  v_mfma_f32_16x16x32_bf16 v[36:39], a[156:159], v[108:111], v[36:39]
  s_waitcnt lgkmcnt(1)
  v_mfma_f32_16x16x32_bf16 v[40:43], a[152:155], v[112:115], v[40:43]
  v_mfma_f32_16x16x32_bf16 v[44:47], a[156:159], v[112:115], v[44:47]
  s_waitcnt lgkmcnt(0)
  v_mfma_f32_16x16x32_bf16 v[48:51], a[152:155], v[116:119], v[48:51]
  v_mfma_f32_16x16x32_bf16 v[52:55], a[156:159], v[116:119], v[52:55]
  s_waitcnt vmcnt(0) lgkmcnt(0)
  s_mul_i32 s62, s3, 3072
  s_add_u32 s60, s68, s62
  s_add_u32 s60, s60, 16384
  v_mov_b32 v164, 0x3f803f80
  v_pk_mul_f32 v[200:201], v[128:129], v[156:157] op_sel:[0,0] op_sel_hi:[1,0]
  v_pk_mul_f32 v[202:203], v[130:131], v[156:157] op_sel:[0,0] op_sel_hi:[1,0]
  v_pk_fma_f32 v[32:33], v[32:33], v[120:121], v[200:201]
  v_pk_fma_f32 v[34:35], v[34:35], v[122:123], v[202:203]
  v_cvt_pk_bf16_f32 v188, v32, v33
  v_cvt_pk_bf16_f32 v189, v34, v35
  v_pk_mul_f32 v[200:201], v[132:133], v[156:157] op_sel:[0,0] op_sel_hi:[1,0]
  v_pk_mul_f32 v[202:203], v[134:135], v[156:157] op_sel:[0,0] op_sel_hi:[1,0]
  v_pk_fma_f32 v[36:37], v[36:37], v[124:125], v[200:201]
  v_pk_fma_f32 v[38:39], v[38:39], v[126:127], v[202:203]
  v_cvt_pk_bf16_f32 v190, v36, v37
  v_cvt_pk_bf16_f32 v191, v38, v39
  buffer_store_dwordx4 v[188:191], v2, s[8:11], s60 offen offset:0 sc1
  v_pk_mul_f32 v[200:201], v[128:129], v[156:157] op_sel:[0,1] op_sel_hi:[1,1]
  v_pk_mul_f32 v[202:203], v[130:131], v[156:157] op_sel:[0,1] op_sel_hi:[1,1]
  v_pk_fma_f32 v[40:41], v[40:41], v[120:121], v[200:201]
  v_pk_fma_f32 v[42:43], v[42:43], v[122:123], v[202:203]
  v_cvt_pk_bf16_f32 v192, v40, v41
  v_cvt_pk_bf16_f32 v193, v42, v43
  v_pk_mul_f32 v[200:201], v[132:133], v[156:157] op_sel:[0,1] op_sel_hi:[1,1]
  v_pk_mul_f32 v[202:203], v[134:135], v[156:157] op_sel:[0,1] op_sel_hi:[1,1]
  v_pk_fma_f32 v[44:45], v[44:45], v[124:125], v[200:201]
  v_pk_fma_f32 v[46:47], v[46:47], v[126:127], v[202:203]
  v_cvt_pk_bf16_f32 v194, v44, v45
  v_cvt_pk_bf16_f32 v195, v46, v47
  buffer_store_dwordx4 v[192:195], v2, s[8:11], s60 offen offset:1024 sc1
  v_pk_mul_f32 v[200:201], v[128:129], v[158:159] op_sel:[0,0] op_sel_hi:[1,0]
  v_pk_mul_f32 v[202:203], v[130:131], v[158:159] op_sel:[0,0] op_sel_hi:[1,0]
  v_pk_fma_f32 v[48:49], v[48:49], v[120:121], v[200:201]
  v_pk_fma_f32 v[50:51], v[50:51], v[122:123], v[202:203]
  v_cvt_pk_bf16_f32 v196, v48, v49
  v_cvt_pk_bf16_f32 v197, v50, v51
  v_pk_mul_f32 v[200:201], v[132:133], v[158:159] op_sel:[0,0] op_sel_hi:[1,0]
  v_pk_mul_f32 v[202:203], v[134:135], v[158:159] op_sel:[0,0] op_sel_hi:[1,0]
  v_pk_fma_f32 v[52:53], v[52:53], v[124:125], v[200:201]
  v_pk_fma_f32 v[54:55], v[54:55], v[126:127], v[202:203]
  v_cvt_pk_bf16_f32 v198, v52, v53
  v_cvt_pk_bf16_f32 v199, v54, v55
  v_cndmask_b32_e64 v196, v164, v196, s[40:41]
  v_cndmask_b32_e64 v197, v164, v197, s[40:41]
  v_cndmask_b32_e64 v198, v164, v198, s[40:41]
  v_cndmask_b32_e64 v199, v164, v199, s[40:41]
  buffer_store_dwordx4 v[196:199], v2, s[8:11], s60 offen offset:2048 sc1
  s_mov_b32 s62, 0
L_kh_26:
  v_cmp_eq_u32 vcc, 1, v250
  s_nop 4
  s_cmp_eq_u64 vcc, -1
  s_cbranch_scc1 L_khd_27
  buffer_load_dword v250, v245, s[8:11], 0 offen offset:0 sc1
  s_waitcnt vmcnt(0)
  s_add_u32 s62, s62, 1
  s_cmp_lt_u32 s62, 400000
  s_cbranch_scc1 L_kh_26
  v_mov_b32 v140, 0xdeaf
  v_mov_b32 v141, 0
  s_mov_b32 s62, 28619264
  buffer_store_dword v140, v141, s[8:11], s62 offen sc1
L_khd_27:
  s_cmp_lt_u32 s20, 2
  s_cbranch_scc1 L_kmiss_28
  s_sub_u32 s64, s68, 57344
  s_lshl_b32 s60, s3, 12
  s_add_u32 s61, s64, s60
  s_add_u32 s60, s60, 51200
  s_mov_b32 m0, s60
  s_nop 0
  buffer_load_dwordx4 v2, s[8:11], s61 offen offset:0 sc1 lds
  buffer_load_dwordx4 v2, s[8:11], s61 offen offset:1024 sc1 lds
  buffer_load_dwordx4 v2, s[8:11], s61 offen offset:2048 sc1 lds
  buffer_load_dwordx4 v2, s[8:11], s61 offen offset:3072 sc1 lds
  s_branch L_knext_29
L_kmiss_28:
  buffer_load_dword v252, v2, s[8:11], s68 offen
  buffer_load_dword v252, v2, s[8:11], s68 offen
  buffer_load_dword v252, v2, s[8:11], s68 offen
  buffer_load_dword v252, v2, s[8:11], s68 offen
  v_mov_b32 v144, 0
  v_mov_b32 v145, 0
  v_mov_b32 v147, 0xf14a
  v_cmp_eq_u32 s[56:57], 3, v9
  s_nop 1
  v_cndmask_b32_e64 v146, 0, v147, s[56:57]
  v_mov_b32 v147, 0
  s_lshl_b32 s60, s3, 12
  s_add_u32 s60, s60, 51200
  v_add_u32 v140, s60, v2
  ds_write_b128 v140, v[144:147] offset:0
  ds_write_b128 v140, v[144:147] offset:1024
  ds_write_b128 v140, v[144:147] offset:2048
  ds_write_b128 v140, v[144:147] offset:3072
L_knext_29:
  s_cmp_lt_u32 s20, 1
  s_cbranch_scc1 L_kmiss_30
  s_sub_u32 s64, s68, 28672
  s_lshl_b32 s60, s3, 12
  s_add_u32 s61, s64, s60
  s_add_u32 s60, s60, 67584
  s_mov_b32 m0, s60
  s_nop 0
  buffer_load_dwordx4 v2, s[8:11], s61 offen offset:0 sc1 lds
  buffer_load_dwordx4 v2, s[8:11], s61 offen offset:1024 sc1 lds
  buffer_load_dwordx4 v2, s[8:11], s61 offen offset:2048 sc1 lds
  buffer_load_dwordx4 v2, s[8:11], s61 offen offset:3072 sc1 lds
  s_branch L_knext_31
L_kmiss_30:
  buffer_load_dword v252, v2, s[8:11], s68 offen
  buffer_load_dword v252, v2, s[8:11], s68 offen
  buffer_load_dword v252, v2, s[8:11], s68 offen
  buffer_load_dword v252, v2, s[8:11], s68 offen
  v_mov_b32 v144, 0
  v_mov_b32 v145, 0
  v_mov_b32 v147, 0xf14a
  v_cmp_eq_u32 s[56:57], 3, v9
  s_nop 1
  v_cndmask_b32_e64 v146, 0, v147, s[56:57]
  v_mov_b32 v147, 0
  s_lshl_b32 s60, s3, 12
  s_add_u32 s60, s60, 67584
  v_add_u32 v140, s60, v2
  ds_write_b128 v140, v[144:147] offset:0
  ds_write_b128 v140, v[144:147] offset:1024
  ds_write_b128 v140, v[144:147] offset:2048
  ds_write_b128 v140, v[144:147] offset:3072
L_knext_31:
  s_mul_i32 s62, s3, 3072
  s_barrier
  v_add_u32 v141, s62, v2
  ds_write_b128 v141, v[188:191] offset:24576
  ds_write_b128 v141, v[192:195] offset:25600
  ds_write_b128 v141, v[196:199] offset:26624
  ds_read_b128 v[96:99], v4 offset:49152
  ds_read_b128 v[100:103], v4 offset:50176
  ds_read_b128 v[104:107], v4 offset:51200
  ds_read_b128 v[108:111], v4 offset:52224
  ds_read_b128 v[112:115], v4 offset:53248
  s_waitcnt lgkmcnt(4)
  v_mfma_f32_16x16x32_bf16 v[32:35], v[96:99], a[0:3], 0
  ds_read_b128 v[116:119], v4 offset:54272
  v_mfma_f32_16x16x32_bf16 v[36:39], v[96:99], a[4:7], 0
  s_waitcnt lgkmcnt(4)
  v_mfma_f32_16x16x32_bf16 v[40:43], v[100:103], a[0:3], 0
  ds_read_b128 v[96:99], v4 offset:55296
  v_mfma_f32_16x16x32_bf16 v[44:47], v[100:103], a[4:7], 0
  s_waitcnt lgkmcnt(4)
  v_mfma_f32_16x16x32_bf16 v[32:35], v[104:107], a[8:11], v[32:35]
  ds_read_b128 v[100:103], v4 offset:56320
  v_mfma_f32_16x16x32_bf16 v[36:39], v[104:107], a[12:15], v[36:39]
  s_waitcnt lgkmcnt(4)
  v_mfma_f32_16x16x32_bf16 v[40:43], v[108:111], a[8:11], v[40:43]
  ds_read_b128 v[104:107], v4 offset:57344
  v_mfma_f32_16x16x32_bf16 v[44:47], v[108:111], a[12:15], v[44:47]
  s_waitcnt lgkmcnt(4)
  v_mfma_f32_16x16x32_bf16 v[32:35], v[112:115], a[16:19], v[32:35]
  ds_read_b128 v[108:111], v4 offset:58368
  v_lshlrev_b32 v199, 4, v9
  v_mfma_f32_16x16x32_bf16 v[36:39], v[112:115], a[20:23], v[36:39]
  s_waitcnt lgkmcnt(4)
  v_mfma_f32_16x16x32_bf16 v[40:43], v[116:119], a[16:19], v[40:43]
  ds_read_b128 v[112:115], v4 offset:59392
  v_add_u32 v199, 156160, v199
  v_mfma_f32_16x16x32_bf16 v[44:47], v[116:119], a[20:23], v[44:47]
  s_waitcnt lgkmcnt(4)
  v_mfma_f32_16x16x32_bf16 v[32:35], v[96:99], a[24:27], v[32:35]
  ds_read_b128 v[116:119], v4 offset:60416
  ds_read_b128 v[144:147], v199 offset:384
  v_mfma_f32_16x16x32_bf16 v[36:39], v[96:99], a[28:31], v[36:39]
  s_waitcnt lgkmcnt(5)
  v_mfma_f32_16x16x32_bf16 v[40:43], v[100:103], a[24:27], v[40:43]
  ds_read_b128 v[96:99], v4 offset:61440
  ds_read_b128 v[148:151], v199 offset:448
  v_mfma_f32_16x16x32_bf16 v[44:47], v[100:103], a[28:31], v[44:47]
  s_waitcnt lgkmcnt(6)
  v_mfma_f32_16x16x32_bf16 v[32:35], v[104:107], a[32:35], v[32:35]
  ds_read_b128 v[100:103], v4 offset:62464
  v_mfma_f32_16x16x32_bf16 v[36:39], v[104:107], a[36:39], v[36:39]
  s_waitcnt lgkmcnt(6)
  v_mfma_f32_16x16x32_bf16 v[40:43], v[108:111], a[32:35], v[40:43]
  ds_read_b128 v[104:107], v4 offset:63488
  v_mfma_f32_16x16x32_bf16 v[44:47], v[108:111], a[36:39], v[44:47]
  s_waitcnt lgkmcnt(6)
  v_mfma_f32_16x16x32_bf16 v[32:35], v[112:115], a[40:43], v[32:35]
  ds_read_b128 v[108:111], v4 offset:64512
  v_mfma_f32_16x16x32_bf16 v[36:39], v[112:115], a[44:47], v[36:39]
  s_waitcnt lgkmcnt(6)
  v_mfma_f32_16x16x32_bf16 v[40:43], v[116:119], a[40:43], v[40:43]
  ds_read_b128 v[112:115], v5 offset:0
  v_mfma_f32_16x16x32_bf16 v[44:47], v[116:119], a[44:47], v[44:47]
  s_waitcnt lgkmcnt(5)
  v_mfma_f32_16x16x32_bf16 v[32:35], v[96:99], a[48:51], v[32:35]
  ds_read_b128 v[116:119], v5 offset:1024
  v_mfma_f32_16x16x32_bf16 v[36:39], v[96:99], a[52:55], v[36:39]
  s_waitcnt lgkmcnt(4)
  v_mfma_f32_16x16x32_bf16 v[40:43], v[100:103], a[48:51], v[40:43]
  ds_read_b128 v[96:99], v5 offset:2048
  v_mfma_f32_16x16x32_bf16 v[44:47], v[100:103], a[52:55], v[44:47]
  s_waitcnt lgkmcnt(4)
  v_mfma_f32_16x16x32_bf16 v[32:35], v[104:107], a[56:59], v[32:35]
  ds_read_b128 v[100:103], v5 offset:3072
  v_mfma_f32_16x16x32_bf16 v[36:39], v[104:107], a[60:63], v[36:39]
  s_waitcnt lgkmcnt(4)
  v_mfma_f32_16x16x32_bf16 v[40:43], v[108:111], a[56:59], v[40:43]
  ds_read_b128 v[104:107], v5 offset:4096
  v_mfma_f32_16x16x32_bf16 v[44:47], v[108:111], a[60:63], v[44:47]
  s_waitcnt lgkmcnt(4)
  v_mfma_f32_16x16x32_bf16 v[32:35], v[112:115], a[64:67], v[32:35]
  ds_read_b128 v[108:111], v5 offset:5120
  v_mfma_f32_16x16x32_bf16 v[36:39], v[112:115], a[68:71], v[36:39]
  s_waitcnt lgkmcnt(4)
  v_mfma_f32_16x16x32_bf16 v[40:43], v[116:119], a[64:67], v[40:43]
  ds_read_b128 v[112:115], v5 offset:6144
  v_mfma_f32_16x16x32_bf16 v[44:47], v[116:119], a[68:71], v[44:47]
  s_waitcnt lgkmcnt(4)
  v_mfma_f32_16x16x32_bf16 v[32:35], v[96:99], a[72:75], v[32:35]
  ds_read_b128 v[116:119], v5 offset:7168
  v_mfma_f32_16x16x32_bf16 v[36:39], v[96:99], a[76:79], v[36:39]
  s_waitcnt lgkmcnt(4)
  v_mfma_f32_16x16x32_bf16 v[40:43], v[100:103], a[72:75], v[40:43]
  ds_read_b128 v[96:99], v5 offset:8192
  v_mfma_f32_16x16x32_bf16 v[44:47], v[100:103], a[76:79], v[44:47]
  s_waitcnt lgkmcnt(4)
  v_mfma_f32_16x16x32_bf16 v[32:35], v[104:107], a[80:83], v[32:35]
  ds_read_b128 v[100:103], v5 offset:9216
  v_mfma_f32_16x16x32_bf16 v[36:39], v[104:107], a[84:87], v[36:39]
  s_waitcnt lgkmcnt(4)
  v_mfma_f32_16x16x32_bf16 v[40:43], v[108:111], a[80:83], v[40:43]
  ds_read_b128 v[104:107], v5 offset:10240
  v_mfma_f32_16x16x32_bf16 v[44:47], v[108:111], a[84:87], v[44:47]
  s_waitcnt lgkmcnt(4)
  v_mfma_f32_16x16x32_bf16 v[32:35], v[112:115], a[88:91], v[32:35]
  ds_read_b128 v[108:111], v5 offset:11264
  s_waitcnt vmcnt(8)
  s_mov_b64 exec, 1
  buffer_store_dwordx4 v[224:227], v218, s[8:11], s69 offen offset:64 sc1
  s_mov_b64 exec, -1
  v_mfma_f32_16x16x32_bf16 v[36:39], v[112:115], a[92:95], v[36:39]
  s_waitcnt lgkmcnt(4)
  v_mfma_f32_16x16x32_bf16 v[40:43], v[116:119], a[88:91], v[40:43]
  ds_read_b128 v[112:115], v5 offset:12288
  v_mfma_f32_16x16x32_bf16 v[44:47], v[116:119], a[92:95], v[44:47]
  s_waitcnt lgkmcnt(4)
  v_mfma_f32_16x16x32_bf16 v[32:35], v[96:99], a[96:99], v[32:35]
  ds_read_b128 v[116:119], v5 offset:13312
  v_mfma_f32_16x16x32_bf16 v[36:39], v[96:99], a[100:103], v[36:39]
  s_waitcnt lgkmcnt(4)
  v_mfma_f32_16x16x32_bf16 v[40:43], v[100:103], a[96:99], v[40:43]
  ds_read_b128 v[96:99], v5 offset:14336
  v_mfma_f32_16x16x32_bf16 v[44:47], v[100:103], a[100:103], v[44:47]
  s_waitcnt lgkmcnt(4)
  v_mfma_f32_16x16x32_bf16 v[32:35], v[104:107], a[104:107], v[32:35]
  ds_read_b128 v[100:103], v5 offset:15360
  v_mfma_f32_16x16x32_bf16 v[36:39], v[104:107], a[108:111], v[36:39]
  s_waitcnt lgkmcnt(4)
  v_mfma_f32_16x16x32_bf16 v[40:43], v[108:111], a[104:107], v[40:43]
  ds_read_b128 v[104:107], v5 offset:16384
  v_mfma_f32_16x16x32_bf16 v[44:47], v[108:111], a[108:111], v[44:47]
  s_waitcnt lgkmcnt(4)
  v_mfma_f32_16x16x32_bf16 v[32:35], v[112:115], a[112:115], v[32:35]
  ds_read_b128 v[108:111], v5 offset:17408
  v_mfma_f32_16x16x32_bf16 v[36:39], v[112:115], a[116:119], v[36:39]
  s_waitcnt lgkmcnt(4)
  v_mfma_f32_16x16x32_bf16 v[40:43], v[116:119], a[112:115], v[40:43]
  ds_read_b128 v[112:115], v5 offset:18432
  v_mfma_f32_16x16x32_bf16 v[44:47], v[116:119], a[116:119], v[44:47]
  s_waitcnt lgkmcnt(4)
  v_mfma_f32_16x16x32_bf16 v[32:35], v[96:99], a[120:123], v[32:35]
  ds_read_b128 v[116:119], v5 offset:19456
  v_mfma_f32_16x16x32_bf16 v[36:39], v[96:99], a[124:127], v[36:39]
  s_waitcnt lgkmcnt(4)
  v_mfma_f32_16x16x32_bf16 v[40:43], v[100:103], a[120:123], v[40:43]
  ds_read_b128 v[96:99], v5 offset:20480
  v_mfma_f32_16x16x32_bf16 v[44:47], v[100:103], a[124:127], v[44:47]
  s_waitcnt lgkmcnt(4)
  v_mfma_f32_16x16x32_bf16 v[32:35], v[104:107], a[128:131], v[32:35]
  ds_read_b128 v[100:103], v5 offset:21504
  v_mfma_f32_16x16x32_bf16 v[36:39], v[104:107], a[132:135], v[36:39]
  s_waitcnt lgkmcnt(4)
  v_mfma_f32_16x16x32_bf16 v[40:43], v[108:111], a[128:131], v[40:43]
  ds_read_b128 v[104:107], v5 offset:22528
  v_mfma_f32_16x16x32_bf16 v[44:47], v[108:111], a[132:135], v[44:47]
  s_waitcnt lgkmcnt(4)
  v_mfma_f32_16x16x32_bf16 v[32:35], v[112:115], a[136:139], v[32:35]
  ds_read_b128 v[108:111], v5 offset:23552
  v_mfma_f32_16x16x32_bf16 v[36:39], v[112:115], a[140:143], v[36:39]
  s_waitcnt lgkmcnt(4)
  v_mfma_f32_16x16x32_bf16 v[40:43], v[116:119], a[136:139], v[40:43]
  v_mfma_f32_16x16x32_bf16 v[44:47], v[116:119], a[140:143], v[44:47]
  s_waitcnt lgkmcnt(3)
  v_mfma_f32_16x16x32_bf16 v[32:35], v[96:99], a[144:147], v[32:35]
  v_mfma_f32_16x16x32_bf16 v[36:39], v[96:99], a[148:151], v[36:39]
  s_waitcnt lgkmcnt(2)
  v_mfma_f32_16x16x32_bf16 v[40:43], v[100:103], a[144:147], v[40:43]
  v_mfma_f32_16x16x32_bf16 v[44:47], v[100:103], a[148:151], v[44:47]
  s_waitcnt lgkmcnt(1)
  v_mfma_f32_16x16x32_bf16 v[32:35], v[104:107], a[152:155], v[32:35]
  buffer_load_dword v250, v245, s[8:11], 0 offen offset:64 sc1
  v_mfma_f32_16x16x32_bf16 v[36:39], v[104:107], a[156:159], v[36:39]
  s_waitcnt lgkmcnt(0)
  v_mfma_f32_16x16x32_bf16 v[40:43], v[108:111], a[152:155], v[40:43]
  v_mfma_f32_16x16x32_bf16 v[44:47], v[108:111], a[156:159], v[44:47]
  s_mov_b32 s60, 0x3ea52b5c
  v_mul_f32 v160, s60, v136
  v_mul_f32 v162, s60, v138
  v_mul_f32 v161, s60, v137
  v_mul_f32 v163, s60, v139
  s_waitcnt lgkmcnt(0)
  v_cmp_eq_u32 s[56:57], 3, v9
  v_mov_b32 v173, 0x3f80
  s_nop 0
  v_cndmask_b32_e64 v172, 0, v173, s[56:57]
  v_pk_mul_f32 v[200:201], v[144:145], v[162:163] op_sel:[0,0] op_sel_hi:[1,0]
  v_pk_mul_f32 v[202:203], v[146:147], v[162:163] op_sel:[0,0] op_sel_hi:[1,0]
  v_pk_fma_f32 v[32:33], v[32:33], v[160:161], v[200:201] op_sel:[0,0,0] op_sel_hi:[1,0,1]
  v_pk_fma_f32 v[34:35], v[34:35], v[160:161], v[202:203] op_sel:[0,0,0] op_sel_hi:[1,0,1]
  v_cvt_pk_bf16_f32 v168, v32, v33
  v_cvt_pk_bf16_f32 v169, v34, v35
  v_cndmask_b32_e64 v170, v172, v184, s[42:43]
  v_cndmask_b32_e64 v171, 0, v185, s[42:43]
  v_accvgpr_write_b32 a180, v168
  v_accvgpr_write_b32 a181, v169
  v_accvgpr_write_b32 a182, v170
  v_accvgpr_write_b32 a183, v171
  v_pk_mul_f32 v[200:201], v[148:149], v[162:163] op_sel:[0,0] op_sel_hi:[1,0]
  v_pk_mul_f32 v[202:203], v[150:151], v[162:163] op_sel:[0,0] op_sel_hi:[1,0]
  v_pk_fma_f32 v[40:41], v[40:41], v[160:161], v[200:201] op_sel:[0,0,0] op_sel_hi:[1,0,1]
  v_pk_fma_f32 v[42:43], v[42:43], v[160:161], v[202:203] op_sel:[0,0,0] op_sel_hi:[1,0,1]
  v_cvt_pk_bf16_f32 v168, v40, v41
  v_cvt_pk_bf16_f32 v169, v42, v43
  v_cndmask_b32_e64 v170, v172, v184, s[44:45]
  v_cndmask_b32_e64 v171, 0, v185, s[44:45]
  v_accvgpr_write_b32 a184, v168
  v_accvgpr_write_b32 a185, v169
  v_accvgpr_write_b32 a186, v170
  v_accvgpr_write_b32 a187, v171
  v_pk_mul_f32 v[200:201], v[144:145], v[162:163] op_sel:[0,1] op_sel_hi:[1,1]
  v_pk_mul_f32 v[202:203], v[146:147], v[162:163] op_sel:[0,1] op_sel_hi:[1,1]
  v_pk_fma_f32 v[36:37], v[36:37], v[160:161], v[200:201] op_sel:[0,1,0] op_sel_hi:[1,1,1]
  v_pk_fma_f32 v[38:39], v[38:39], v[160:161], v[202:203] op_sel:[0,1,0] op_sel_hi:[1,1,1]
  v_cvt_pk_bf16_f32 v168, v36, v37
  v_cvt_pk_bf16_f32 v169, v38, v39
  v_cndmask_b32_e64 v170, v172, v186, s[42:43]
  v_cndmask_b32_e64 v171, 0, v187, s[42:43]
  v_accvgpr_write_b32 a188, v168
  v_accvgpr_write_b32 a189, v169
  v_accvgpr_write_b32 a190, v170
  v_accvgpr_write_b32 a191, v171
  v_pk_mul_f32 v[200:201], v[148:149], v[162:163] op_sel:[0,1] op_sel_hi:[1,1]
  v_pk_mul_f32 v[202:203], v[150:151], v[162:163] op_sel:[0,1] op_sel_hi:[1,1]
  v_pk_fma_f32 v[44:45], v[44:45], v[160:161], v[200:201] op_sel:[0,1,0] op_sel_hi:[1,1,1]
  v_pk_fma_f32 v[46:47], v[46:47], v[160:161], v[202:203] op_sel:[0,1,0] op_sel_hi:[1,1,1]
  v_cvt_pk_bf16_f32 v168, v44, v45
  v_cvt_pk_bf16_f32 v169, v46, v47
  v_cndmask_b32_e64 v170, v172, v186, s[44:45]
  v_cndmask_b32_e64 v171, 0, v187, s[44:45]
  v_accvgpr_write_b32 a192, v168
  v_accvgpr_write_b32 a193, v169
  v_accvgpr_write_b32 a194, v170
  v_accvgpr_write_b32 a195, v171
  s_waitcnt vmcnt(1)
  s_waitcnt lgkmcnt(0)
  s_barrier
  s_lshl_b32 s60, s3, 12
  s_add_u32 s60, s60, 51200
  v_add_u32 v242, s60, v2
  s_mul_i32 s60, s3, 3072
  s_add_u32 s60, s60, 0
  v_add_u32 v243, s60, v2
  ds_read_b128 a[0:3], v242 offset:0
  ds_read_b128 a[4:7], v242 offset:2048
  ds_read_b128 a[8:11], v242 offset:4096
  ds_read_b128 a[12:15], v242 offset:6144
  ds_read_b128 a[16:19], v242 offset:8192
  ds_read_b128 a[20:23], v242 offset:10240
  ds_read_b128 a[24:27], v242 offset:12288
  ds_read_b128 a[28:31], v242 offset:14336
  ds_read_b128 a[32:35], v242 offset:16384
  ds_read_b128 a[36:39], v242 offset:18432
  ds_read_b128 a[40:43], v242 offset:20480
  ds_read_b128 a[44:47], v242 offset:22528
  v_mov_b32 v246, 0xf149f2ca
  v_lshlrev_b32 v247, 2, v9
  v_add_u32 v248, 0, v247
  v_cmp_le_u32 s[56:57], v248, v10
  s_nop 1
  v_cndmask_b32_e64 v212, v246, 0, s[56:57]
  v_cndmask_b32_e64 v216, 0, v246, s[56:57]
  v_add_u32 v248, 1, v247
  v_cmp_le_u32 s[56:57], v248, v10
  s_nop 1
  v_cndmask_b32_e64 v213, v246, 0, s[56:57]
  v_cndmask_b32_e64 v217, 0, v246, s[56:57]
  v_add_u32 v248, 2, v247
  v_cmp_le_u32 s[56:57], v248, v10
  s_nop 1
  v_cndmask_b32_e64 v214, v246, 0, s[56:57]
  v_cndmask_b32_e64 v218, 0, v246, s[56:57]
  v_add_u32 v248, 3, v247
  v_cmp_le_u32 s[56:57], v248, v10
  s_nop 1
  v_cndmask_b32_e64 v215, v246, 0, s[56:57]
  v_cndmask_b32_e64 v219, 0, v246, s[56:57]
  s_mul_i32 s60, s28, 2621440
  s_add_u32 s70, s76, s60
  s_add_u32 s71, s77, s60
  v_and_b32 v244, 1, v9
  v_lshlrev_b32 v244, 3, v244
  v_lshl_add_u32 v244, v10, 4, v244
  s_waitcnt vmcnt(0)
  s_mov_b32 s62, 0
L_vh_32:
  v_cmp_eq_u32 vcc, 1, v250
  s_nop 4
  s_cmp_eq_u64 vcc, -1
  s_cbranch_scc1 L_vhd_33
  buffer_load_dword v250, v245, s[8:11], 0 offen offset:64 sc1
  s_waitcnt vmcnt(0)
  s_add_u32 s62, s62, 1
  s_cmp_lt_u32 s62, 400000
  s_cbranch_scc1 L_vh_32
  v_mov_b32 v140, 0xdeaf
  v_mov_b32 v141, 0
  s_mov_b32 s62, 28619264
  buffer_store_dword v140, v141, s[8:11], s62 offen sc1
L_vhd_33:
  s_cmp_lt_u32 s20, 2
  s_cbranch_scc1 L_vmiss_34
  s_sub_u32 s64, s68, 57344
  s_mul_i32 s60, s3, 3072
  s_add_u32 s61, s64, s60
  s_add_u32 s61, s61, 16384
  s_add_u32 s60, s60, 0
  s_mov_b32 m0, s60
  s_nop 0
  buffer_load_dwordx4 v2, s[8:11], s61 offen offset:0 sc1 lds
  buffer_load_dwordx4 v2, s[8:11], s61 offen offset:1024 sc1 lds
  buffer_load_dwordx4 v2, s[8:11], s61 offen offset:2048 sc1 lds
  s_branch L_vnext_35
L_vmiss_34:
  v_mov_b32 v144, 0
  v_mov_b32 v145, 0
  v_mov_b32 v146, 0
  v_mov_b32 v147, 0
  s_mul_i32 s60, s3, 3072
  s_add_u32 s60, s60, 0
  v_add_u32 v140, s60, v2
  ds_write_b128 v140, v[144:147] offset:0
  ds_write_b128 v140, v[144:147] offset:1024
  ds_write_b128 v140, v[144:147] offset:2048
  s_waitcnt lgkmcnt(0)
L_vnext_35:
  s_cmp_lt_u32 s20, 1
  s_cbranch_scc1 L_vmiss_36
  s_sub_u32 s64, s68, 28672
  s_mul_i32 s60, s3, 3072
  s_add_u32 s61, s64, s60
  s_add_u32 s61, s61, 16384
  s_add_u32 s60, s60, 12288
  s_mov_b32 m0, s60
  s_nop 0
  buffer_load_dwordx4 v2, s[8:11], s61 offen offset:0 sc1 lds
  buffer_load_dwordx4 v2, s[8:11], s61 offen offset:1024 sc1 lds
  buffer_load_dwordx4 v2, s[8:11], s61 offen offset:2048 sc1 lds
  s_branch L_vnext_37
L_vmiss_36:
  v_mov_b32 v144, 0
  v_mov_b32 v145, 0
  v_mov_b32 v146, 0
  v_mov_b32 v147, 0
  s_mul_i32 s60, s3, 3072
  s_add_u32 s60, s60, 12288
  v_add_u32 v140, s60, v2
  ds_write_b128 v140, v[144:147] offset:0
  ds_write_b128 v140, v[144:147] offset:1024
  ds_write_b128 v140, v[144:147] offset:2048
  s_waitcnt lgkmcnt(0)
L_vnext_37:
  s_waitcnt lgkmcnt(8)
  v_mfma_f32_16x16x32_bf16 v[32:35], a[0:3], a[180:183], v[216:219]
  ds_read_b128 a[48:51], v242 offset:24576
  v_mfma_f32_16x16x32_bf16 v[36:39], a[4:7], a[180:183], 0
  ds_read_b128 a[52:55], v242 offset:26624
  v_mfma_f32_16x16x32_bf16 v[40:43], a[8:11], a[180:183], 0
  ds_read_b128 a[56:59], v242 offset:28672
  v_mfma_f32_16x16x32_bf16 v[44:47], a[12:15], a[180:183], 0
  ds_read_b128 a[60:63], v242 offset:30720
  s_waitcnt lgkmcnt(8)
  v_mfma_f32_16x16x32_bf16 v[48:51], a[16:19], a[180:183], 0
  ds_read_b128 a[64:67], v242 offset:32768
  v_mfma_f32_16x16x32_bf16 v[52:55], a[20:23], a[180:183], 0
  ds_read_b128 a[68:71], v242 offset:34816
  v_mfma_f32_16x16x32_bf16 v[56:59], a[24:27], a[180:183], 0
  v_mfma_f32_16x16x32_bf16 v[60:63], a[28:31], a[180:183], 0
  s_waitcnt lgkmcnt(6)
  v_mfma_f32_16x16x32_bf16 v[64:67], a[32:35], a[180:183], 0
  v_mfma_f32_16x16x32_bf16 v[68:71], a[36:39], a[180:183], 0
  v_mfma_f32_16x16x32_bf16 v[72:75], a[40:43], a[180:183], 0
  v_mfma_f32_16x16x32_bf16 v[76:79], a[44:47], a[180:183], 0
  s_waitcnt lgkmcnt(2)
  v_mfma_f32_16x16x32_bf16 v[80:83], a[48:51], a[180:183], 0
  v_mfma_f32_16x16x32_bf16 v[84:87], a[52:55], a[180:183], 0
  v_mfma_f32_16x16x32_bf16 v[88:91], a[56:59], a[180:183], 0
  v_mfma_f32_16x16x32_bf16 v[92:95], a[60:63], a[180:183], 0
  s_waitcnt lgkmcnt(0)
  v_mfma_f32_16x16x32_bf16 v[96:99], a[64:67], a[180:183], v[212:215]
  v_max3_f32 v222, v32, v33, v34
  v_max3_f32 v223, v49, v50, v51
  v_max3_f32 v224, v66, v67, v68
  s_nop 0
  v_max3_f32 v225, v83, v84, v85
  v_max3_f32 v222, v222, v35, v36
  v_max3_f32 v223, v223, v52, v53
  v_max3_f32 v224, v224, v69, v70
  v_max3_f32 v225, v225, v86, v87
  v_max3_f32 v222, v222, v37, v38
  v_max3_f32 v223, v223, v54, v55
  v_max3_f32 v224, v224, v71, v72
  v_max3_f32 v225, v225, v88, v89
  v_max3_f32 v222, v222, v39, v40
  v_max3_f32 v223, v223, v56, v57
  v_max3_f32 v224, v224, v73, v74
  v_max3_f32 v225, v225, v90, v91
  v_max3_f32 v222, v222, v41, v42
  v_max3_f32 v223, v223, v58, v59
  v_max3_f32 v224, v224, v75, v76
  v_max3_f32 v225, v225, v92, v93
  v_max3_f32 v222, v222, v43, v44
  v_max3_f32 v223, v223, v60, v61
  v_max3_f32 v224, v224, v77, v78
  v_max3_f32 v225, v225, v94, v95
  v_max3_f32 v222, v222, v45, v46
  v_max3_f32 v223, v223, v62, v63
  v_max3_f32 v224, v224, v79, v80
  v_max3_f32 v225, v225, v96, v97
  v_max3_f32 v222, v222, v47, v48
  v_max3_f32 v223, v223, v64, v65
  v_max3_f32 v224, v224, v81, v82
  v_max3_f32 v225, v225, v98, v99
  v_max3_f32 v220, v222, v223, v224
  v_max_f32 v220, v220, v225
  v_mov_b32 v226, v220
  s_nop 1
  v_permlane32_swap_b32 v220, v226
  v_max_f32 v220, v220, v226
  v_mov_b32 v226, v220
  s_nop 1
  v_permlane16_swap_b32 v220, v226
  v_max_f32 v220, v220, v226
  v_pk_add_f32 v[32:33], v[32:33], v[220:221] op_sel_hi:[1,0] neg_lo:[0,1] neg_hi:[0,1]
  v_pk_add_f32 v[34:35], v[34:35], v[220:221] op_sel_hi:[1,0] neg_lo:[0,1] neg_hi:[0,1]
  v_pk_add_f32 v[36:37], v[36:37], v[220:221] op_sel_hi:[1,0] neg_lo:[0,1] neg_hi:[0,1]
  v_pk_add_f32 v[38:39], v[38:39], v[220:221] op_sel_hi:[1,0] neg_lo:[0,1] neg_hi:[0,1]
  v_mfma_f32_16x16x32_bf16 v[100:103], a[4:7], a[188:191], v[216:219]
  v_exp_f32 v32, v32
  v_exp_f32 v33, v33
  v_exp_f32 v34, v34
  v_exp_f32 v35, v35
  v_pk_add_f32 v[40:41], v[40:41], v[220:221] op_sel_hi:[1,0] neg_lo:[0,1] neg_hi:[0,1]
  v_pk_add_f32 v[42:43], v[42:43], v[220:221] op_sel_hi:[1,0] neg_lo:[0,1] neg_hi:[0,1]
  v_mfma_f32_16x16x32_bf16 v[104:107], a[8:11], a[188:191], 0
  v_exp_f32 v36, v36
  v_exp_f32 v37, v37
  v_exp_f32 v38, v38
  v_exp_f32 v39, v39
  v_pk_add_f32 v[44:45], v[44:45], v[220:221] op_sel_hi:[1,0] neg_lo:[0,1] neg_hi:[0,1]
  v_pk_add_f32 v[46:47], v[46:47], v[220:221] op_sel_hi:[1,0] neg_lo:[0,1] neg_hi:[0,1]
  v_cvt_pk_bf16_f32 v168, v32, v33
  v_cvt_pk_bf16_f32 v169, v34, v35
  v_mfma_f32_16x16x32_bf16 v[108:111], a[12:15], a[188:191], 0
  v_exp_f32 v40, v40
  v_exp_f32 v41, v41
  v_exp_f32 v42, v42
  v_exp_f32 v43, v43
  v_pk_add_f32 v[48:49], v[48:49], v[220:221] op_sel_hi:[1,0] neg_lo:[0,1] neg_hi:[0,1]
  v_pk_add_f32 v[50:51], v[50:51], v[220:221] op_sel_hi:[1,0] neg_lo:[0,1] neg_hi:[0,1]
  v_cvt_pk_bf16_f32 v170, v36, v37
  v_cvt_pk_bf16_f32 v171, v38, v39
  v_mfma_f32_16x16x32_bf16 v[112:115], a[16:19], a[188:191], 0
  v_exp_f32 v44, v44
  v_exp_f32 v45, v45
  v_exp_f32 v46, v46
  v_exp_f32 v47, v47
  v_pk_add_f32 v[52:53], v[52:53], v[220:221] op_sel_hi:[1,0] neg_lo:[0,1] neg_hi:[0,1]
  v_pk_add_f32 v[54:55], v[54:55], v[220:221] op_sel_hi:[1,0] neg_lo:[0,1] neg_hi:[0,1]
  v_cvt_pk_bf16_f32 v172, v40, v41
  v_cvt_pk_bf16_f32 v173, v42, v43
  v_mfma_f32_16x16x32_bf16 v[116:119], a[20:23], a[188:191], 0
  v_exp_f32 v48, v48
  v_exp_f32 v49, v49
  v_exp_f32 v50, v50
  v_exp_f32 v51, v51
  v_pk_add_f32 v[56:57], v[56:57], v[220:221] op_sel_hi:[1,0] neg_lo:[0,1] neg_hi:[0,1]
  v_pk_add_f32 v[58:59], v[58:59], v[220:221] op_sel_hi:[1,0] neg_lo:[0,1] neg_hi:[0,1]
  v_cvt_pk_bf16_f32 v174, v44, v45
  v_cvt_pk_bf16_f32 v175, v46, v47
  v_mfma_f32_16x16x32_bf16 v[120:123], a[24:27], a[188:191], 0
  v_exp_f32 v52, v52
  v_exp_f32 v53, v53
  v_exp_f32 v54, v54
  v_exp_f32 v55, v55
  v_pk_add_f32 v[60:61], v[60:61], v[220:221] op_sel_hi:[1,0] neg_lo:[0,1] neg_hi:[0,1]
  v_pk_add_f32 v[62:63], v[62:63], v[220:221] op_sel_hi:[1,0] neg_lo:[0,1] neg_hi:[0,1]
  v_cvt_pk_bf16_f32 v176, v48, v49
  v_cvt_pk_bf16_f32 v177, v50, v51
  v_mfma_f32_16x16x32_bf16 v[124:127], a[28:31], a[188:191], 0
  v_exp_f32 v56, v56
  v_exp_f32 v57, v57
  v_exp_f32 v58, v58
  v_exp_f32 v59, v59
  v_pk_add_f32 v[64:65], v[64:65], v[220:221] op_sel_hi:[1,0] neg_lo:[0,1] neg_hi:[0,1]
  v_pk_add_f32 v[66:67], v[66:67], v[220:221] op_sel_hi:[1,0] neg_lo:[0,1] neg_hi:[0,1]
  v_cvt_pk_bf16_f32 v178, v52, v53
  v_cvt_pk_bf16_f32 v179, v54, v55
  v_mfma_f32_16x16x32_bf16 v[128:131], a[32:35], a[188:191], 0
  v_exp_f32 v60, v60
  v_exp_f32 v61, v61
  v_exp_f32 v62, v62
  v_exp_f32 v63, v63
  v_pk_add_f32 v[68:69], v[68:69], v[220:221] op_sel_hi:[1,0] neg_lo:[0,1] neg_hi:[0,1]
  v_pk_add_f32 v[70:71], v[70:71], v[220:221] op_sel_hi:[1,0] neg_lo:[0,1] neg_hi:[0,1]
  v_cvt_pk_bf16_f32 v180, v56, v57
  v_cvt_pk_bf16_f32 v181, v58, v59
  v_mfma_f32_16x16x32_bf16 v[132:135], a[36:39], a[188:191], 0
  v_exp_f32 v64, v64
  v_exp_f32 v65, v65
  v_exp_f32 v66, v66
  v_exp_f32 v67, v67
  v_pk_add_f32 v[72:73], v[72:73], v[220:221] op_sel_hi:[1,0] neg_lo:[0,1] neg_hi:[0,1]
  v_pk_add_f32 v[74:75], v[74:75], v[220:221] op_sel_hi:[1,0] neg_lo:[0,1] neg_hi:[0,1]
  v_cvt_pk_bf16_f32 v182, v60, v61
  v_cvt_pk_bf16_f32 v183, v62, v63
  v_mfma_f32_16x16x32_bf16 v[136:139], a[40:43], a[188:191], 0
  v_exp_f32 v68, v68
  v_exp_f32 v69, v69
  v_exp_f32 v70, v70
  v_exp_f32 v71, v71
  v_pk_add_f32 v[76:77], v[76:77], v[220:221] op_sel_hi:[1,0] neg_lo:[0,1] neg_hi:[0,1]
  v_pk_add_f32 v[78:79], v[78:79], v[220:221] op_sel_hi:[1,0] neg_lo:[0,1] neg_hi:[0,1]
  v_cvt_pk_bf16_f32 v184, v64, v65
  v_cvt_pk_bf16_f32 v185, v66, v67
  v_mfma_f32_16x16x32_bf16 v[140:143], a[44:47], a[188:191], 0
  v_exp_f32 v72, v72
  v_exp_f32 v73, v73
  v_exp_f32 v74, v74
  v_exp_f32 v75, v75
  v_pk_add_f32 v[80:81], v[80:81], v[220:221] op_sel_hi:[1,0] neg_lo:[0,1] neg_hi:[0,1]
  v_pk_add_f32 v[82:83], v[82:83], v[220:221] op_sel_hi:[1,0] neg_lo:[0,1] neg_hi:[0,1]
  v_cvt_pk_bf16_f32 v186, v68, v69
  v_cvt_pk_bf16_f32 v187, v70, v71
  v_mfma_f32_16x16x32_bf16 v[144:147], a[48:51], a[188:191], 0
  v_exp_f32 v76, v76
  v_exp_f32 v77, v77
  v_exp_f32 v78, v78
  v_exp_f32 v79, v79
  v_pk_add_f32 v[84:85], v[84:85], v[220:221] op_sel_hi:[1,0] neg_lo:[0,1] neg_hi:[0,1]
  v_pk_add_f32 v[86:87], v[86:87], v[220:221] op_sel_hi:[1,0] neg_lo:[0,1] neg_hi:[0,1]
  v_cvt_pk_bf16_f32 v188, v72, v73
  v_cvt_pk_bf16_f32 v189, v74, v75
  v_mfma_f32_16x16x32_bf16 v[148:151], a[52:55], a[188:191], 0
  s_waitcnt vmcnt(0)
  s_barrier
  ds_read_b128 a[72:75], v243 offset:0
  ds_read_b128 a[144:147], v243 offset:2048
  ds_read_b128 a[76:79], v243 offset:3072
  ds_read_b128 a[148:151], v243 offset:5120
  v_exp_f32 v80, v80
  v_exp_f32 v81, v81
  v_exp_f32 v82, v82
  v_exp_f32 v83, v83
  v_pk_add_f32 v[88:89], v[88:89], v[220:221] op_sel_hi:[1,0] neg_lo:[0,1] neg_hi:[0,1]
  v_pk_add_f32 v[90:91], v[90:91], v[220:221] op_sel_hi:[1,0] neg_lo:[0,1] neg_hi:[0,1]
  v_cvt_pk_bf16_f32 v190, v76, v77
  v_cvt_pk_bf16_f32 v191, v78, v79
  v_mfma_f32_16x16x32_bf16 v[152:155], a[56:59], a[188:191], 0
  ds_read_b128 a[80:83], v243 offset:6144
  ds_read_b128 a[152:155], v243 offset:8192
  ds_read_b128 a[84:87], v243 offset:9216
  ds_read_b128 a[156:159], v243 offset:11264
  v_exp_f32 v84, v84
  v_exp_f32 v85, v85
  v_exp_f32 v86, v86
  v_exp_f32 v87, v87
  v_pk_add_f32 v[92:93], v[92:93], v[220:221] op_sel_hi:[1,0] neg_lo:[0,1] neg_hi:[0,1]
  v_pk_add_f32 v[94:95], v[94:95], v[220:221] op_sel_hi:[1,0] neg_lo:[0,1] neg_hi:[0,1]
  v_cvt_pk_bf16_f32 v192, v80, v81
  v_cvt_pk_bf16_f32 v193, v82, v83
  v_mfma_f32_16x16x32_bf16 v[156:159], a[60:63], a[188:191], 0
  ds_read_b128 a[88:91], v243 offset:12288
  ds_read_b128 a[160:163], v243 offset:14336
  ds_read_b128 a[92:95], v243 offset:15360
  ds_read_b128 a[164:167], v243 offset:17408
  v_exp_f32 v88, v88
  v_exp_f32 v89, v89
  v_exp_f32 v90, v90
  v_exp_f32 v91, v91
  v_pk_add_f32 v[96:97], v[96:97], v[220:221] op_sel_hi:[1,0] neg_lo:[0,1] neg_hi:[0,1]
  v_pk_add_f32 v[98:99], v[98:99], v[220:221] op_sel_hi:[1,0] neg_lo:[0,1] neg_hi:[0,1]
  v_cvt_pk_bf16_f32 v194, v84, v85
  v_cvt_pk_bf16_f32 v195, v86, v87
  v_mfma_f32_16x16x32_bf16 v[160:163], a[64:67], a[188:191], 0
  ds_read_b128 a[96:99], v243 offset:18432
  ds_read_b128 a[168:171], v243 offset:20480
  ds_read_b128 a[100:103], v243 offset:21504
  s_waitcnt lgkmcnt(14)
  ds_read_b128 a[172:175], v243 offset:23552
  v_exp_f32 v92, v92
  v_exp_f32 v93, v93
  v_exp_f32 v94, v94
  v_exp_f32 v95, v95
  v_cvt_pk_bf16_f32 v196, v88, v89
  v_cvt_pk_bf16_f32 v197, v90, v91
  v_mfma_f32_16x16x32_bf16 v[164:167], a[68:71], a[188:191], v[212:215]
  s_waitcnt lgkmcnt(14)
  ds_read_b128 a[104:107], v243 offset:24576
  s_waitcnt lgkmcnt(14)
  ds_read_b128 a[176:179], v243 offset:26624
  v_exp_f32 v96, v96
  v_exp_f32 v97, v97
  v_exp_f32 v98, v98
  v_exp_f32 v99, v99
  v_cvt_pk_bf16_f32 v198, v92, v93
  v_cvt_pk_bf16_f32 v199, v94, v95
  v_cvt_pk_bf16_f32 v200, v96, v97
  v_cvt_pk_bf16_f32 v201, v98, v99
  v_mov_b32 v202, 0
  v_mov_b32 v203, 0
  v_max3_f32 v222, v100, v101, v102
  v_mfma_f32_16x16x32_bf16 v[204:207], a[72:75], v[168:171], 0
  v_max3_f32 v223, v117, v118, v119
  v_max3_f32 v224, v134, v135, v136
  v_mfma_f32_16x16x32_bf16 v[208:211], a[144:147], v[168:171], 0
  v_max3_f32 v225, v151, v152, v153
  v_max3_f32 v222, v222, v103, v104
  v_mfma_f32_16x16x32_bf16 v[204:207], a[76:79], v[172:175], v[204:207]
  v_max3_f32 v223, v223, v120, v121
  v_max3_f32 v224, v224, v137, v138
  s_waitcnt lgkmcnt(14)
  v_mfma_f32_16x16x32_bf16 v[208:211], a[148:151], v[172:175], v[208:211]
  v_max3_f32 v225, v225, v154, v155
  v_max3_f32 v222, v222, v105, v106
  s_waitcnt lgkmcnt(13)
  v_mfma_f32_16x16x32_bf16 v[204:207], a[80:83], v[176:179], v[204:207]
  v_max3_f32 v223, v223, v122, v123
  v_max3_f32 v224, v224, v139, v140
  v_max3_f32 v225, v225, v156, v157
  s_waitcnt lgkmcnt(12)
  v_mfma_f32_16x16x32_bf16 v[208:211], a[152:155], v[176:179], v[208:211]
  v_max3_f32 v222, v222, v107, v108
  v_max3_f32 v223, v223, v124, v125
  s_waitcnt lgkmcnt(11)
  v_mfma_f32_16x16x32_bf16 v[204:207], a[84:87], v[180:183], v[204:207]
  v_max3_f32 v224, v224, v141, v142
  v_max3_f32 v225, v225, v158, v159
  s_waitcnt lgkmcnt(10)
  v_mfma_f32_16x16x32_bf16 v[208:211], a[156:159], v[180:183], v[208:211]
  v_max3_f32 v222, v222, v109, v110
  v_max3_f32 v223, v223, v126, v127
  s_waitcnt lgkmcnt(9)
  v_mfma_f32_16x16x32_bf16 v[204:207], a[88:91], v[184:187], v[204:207]
  v_max3_f32 v224, v224, v143, v144
  v_max3_f32 v225, v225, v160, v161
  v_max3_f32 v222, v222, v111, v112
  s_waitcnt lgkmcnt(8)
  v_mfma_f32_16x16x32_bf16 v[208:211], a[160:163], v[184:187], v[208:211]
  v_max3_f32 v223, v223, v128, v129
  v_max3_f32 v224, v224, v145, v146
  s_waitcnt lgkmcnt(7)
  v_mfma_f32_16x16x32_bf16 v[204:207], a[92:95], v[188:191], v[204:207]
  v_max3_f32 v225, v225, v162, v163
  v_max3_f32 v222, v222, v113, v114
  s_waitcnt lgkmcnt(6)
  v_mfma_f32_16x16x32_bf16 v[208:211], a[164:167], v[188:191], v[208:211]
  v_max3_f32 v223, v223, v130, v131
  v_max3_f32 v224, v224, v147, v148
  s_waitcnt lgkmcnt(5)
  v_mfma_f32_16x16x32_bf16 v[204:207], a[96:99], v[192:195], v[204:207]
  v_max3_f32 v225, v225, v164, v165
  v_max3_f32 v222, v222, v115, v116
  s_waitcnt lgkmcnt(4)
  v_mfma_f32_16x16x32_bf16 v[208:211], a[168:171], v[192:195], v[208:211]
  v_max3_f32 v223, v223, v132, v133
  v_max3_f32 v224, v224, v149, v150
  v_max3_f32 v225, v225, v166, v167
  s_waitcnt lgkmcnt(3)
  v_mfma_f32_16x16x32_bf16 v[204:207], a[100:103], v[196:199], v[204:207]
  v_max3_f32 v220, v222, v223, v224
  v_max_f32 v220, v220, v225
  s_waitcnt lgkmcnt(2)
  v_mfma_f32_16x16x32_bf16 v[208:211], a[172:175], v[196:199], v[208:211]
  v_mov_b32 v226, v220
  s_nop 1
  v_permlane32_swap_b32 v220, v226
  s_waitcnt lgkmcnt(1)
  v_mfma_f32_16x16x32_bf16 v[204:207], a[104:107], v[200:203], v[204:207]
  v_max_f32 v220, v220, v226
  v_mov_b32 v226, v220
  s_waitcnt lgkmcnt(0)
  v_mfma_f32_16x16x32_bf16 v[208:211], a[176:179], v[200:203], v[208:211]
  v_permlane16_swap_b32 v220, v226
  v_max_f32 v220, v220, v226
  ds_read_b128 a[0:3], v242 offset:1024
  ds_read_b128 a[4:7], v242 offset:3072
  ds_read_b128 a[8:11], v242 offset:5120
  ds_read_b128 a[12:15], v242 offset:7168
  ds_read_b128 a[16:19], v242 offset:9216
  ds_read_b128 a[20:23], v242 offset:11264
  ds_read_b128 a[24:27], v242 offset:13312
  ds_read_b128 a[28:31], v242 offset:15360
  ds_read_b128 a[32:35], v242 offset:17408
  ds_read_b128 a[36:39], v242 offset:19456
  ds_read_b128 a[40:43], v242 offset:21504
  ds_read_b128 a[44:47], v242 offset:23552
  v_pk_add_f32 v[100:101], v[100:101], v[220:221] op_sel_hi:[1,0] neg_lo:[0,1] neg_hi:[0,1]
  v_pk_add_f32 v[102:103], v[102:103], v[220:221] op_sel_hi:[1,0] neg_lo:[0,1] neg_hi:[0,1]
  v_pk_add_f32 v[104:105], v[104:105], v[220:221] op_sel_hi:[1,0] neg_lo:[0,1] neg_hi:[0,1]
  v_pk_add_f32 v[106:107], v[106:107], v[220:221] op_sel_hi:[1,0] neg_lo:[0,1] neg_hi:[0,1]
  s_waitcnt lgkmcnt(8)
  v_mfma_f32_16x16x32_bf16 v[32:35], a[0:3], a[184:187], v[216:219]
  ds_read_b128 a[48:51], v242 offset:25600
  v_exp_f32 v100, v100
  v_exp_f32 v101, v101
  v_exp_f32 v102, v102
  v_exp_f32 v103, v103
  v_pk_add_f32 v[108:109], v[108:109], v[220:221] op_sel_hi:[1,0] neg_lo:[0,1] neg_hi:[0,1]
  v_pk_add_f32 v[110:111], v[110:111], v[220:221] op_sel_hi:[1,0] neg_lo:[0,1] neg_hi:[0,1]
  v_mfma_f32_16x16x32_bf16 v[36:39], a[4:7], a[184:187], 0
  ds_read_b128 a[52:55], v242 offset:27648
  v_exp_f32 v104, v104
  v_exp_f32 v105, v105
  v_exp_f32 v106, v106
  v_exp_f32 v107, v107
  v_pk_add_f32 v[112:113], v[112:113], v[220:221] op_sel_hi:[1,0] neg_lo:[0,1] neg_hi:[0,1]
  v_pk_add_f32 v[114:115], v[114:115], v[220:221] op_sel_hi:[1,0] neg_lo:[0,1] neg_hi:[0,1]
  v_cvt_pk_bf16_f32 v170, v100, v101
  v_cvt_pk_bf16_f32 v171, v102, v103
  v_mov_b32 v226, v208
  v_mov_b32 v227, v208
  s_nop 1
  v_permlane32_swap_b32 v227, v226
  v_rcp_f32 v226, v226
  s_nop 0
  v_pk_mul_f32 v[204:205], v[204:205], v[226:227] op_sel_hi:[1,0]
  v_pk_mul_f32 v[208:209], v[208:209], v[226:227] op_sel_hi:[1,0]
  v_pk_mul_f32 v[206:207], v[206:207], v[226:227] op_sel_hi:[1,0]
  v_pk_mul_f32 v[210:211], v[210:211], v[226:227] op_sel_hi:[1,0]
  v_cvt_pk_bf16_f32 v230, v204, v205
  v_cvt_pk_bf16_f32 v231, v206, v207
  v_cvt_pk_bf16_f32 v238, v208, v209
  v_cvt_pk_bf16_f32 v239, v210, v211
  v_mfma_f32_16x16x32_bf16 v[40:43], a[8:11], a[184:187], 0
  ds_read_b128 a[56:59], v242 offset:29696
  v_exp_f32 v108, v108
  v_exp_f32 v109, v109
  v_exp_f32 v110, v110
  v_exp_f32 v111, v111
  v_pk_add_f32 v[116:117], v[116:117], v[220:221] op_sel_hi:[1,0] neg_lo:[0,1] neg_hi:[0,1]
  v_pk_add_f32 v[118:119], v[118:119], v[220:221] op_sel_hi:[1,0] neg_lo:[0,1] neg_hi:[0,1]
  v_cvt_pk_bf16_f32 v172, v104, v105
  v_cvt_pk_bf16_f32 v173, v106, v107
  v_mfma_f32_16x16x32_bf16 v[44:47], a[12:15], a[184:187], 0
  ds_read_b128 a[60:63], v242 offset:31744
  v_exp_f32 v112, v112
  v_exp_f32 v113, v113
  v_exp_f32 v114, v114
  v_exp_f32 v115, v115
  v_pk_add_f32 v[120:121], v[120:121], v[220:221] op_sel_hi:[1,0] neg_lo:[0,1] neg_hi:[0,1]
  v_pk_add_f32 v[122:123], v[122:123], v[220:221] op_sel_hi:[1,0] neg_lo:[0,1] neg_hi:[0,1]
  v_cvt_pk_bf16_f32 v174, v108, v109
  v_cvt_pk_bf16_f32 v175, v110, v111
  s_waitcnt lgkmcnt(8)
  v_mfma_f32_16x16x32_bf16 v[48:51], a[16:19], a[184:187], 0
  ds_read_b128 a[64:67], v242 offset:33792
  v_exp_f32 v116, v116
  v_exp_f32 v117, v117
  v_exp_f32 v118, v118
  v_exp_f32 v119, v119
  v_pk_add_f32 v[124:125], v[124:125], v[220:221] op_sel_hi:[1,0] neg_lo:[0,1] neg_hi:[0,1]
  v_pk_add_f32 v[126:127], v[126:127], v[220:221] op_sel_hi:[1,0] neg_lo:[0,1] neg_hi:[0,1]
  v_cvt_pk_bf16_f32 v176, v112, v113
  v_cvt_pk_bf16_f32 v177, v114, v115
  v_mfma_f32_16x16x32_bf16 v[52:55], a[20:23], a[184:187], 0
  ds_read_b128 a[68:71], v242 offset:35840
  v_exp_f32 v120, v120
  v_exp_f32 v121, v121
  v_exp_f32 v122, v122
  v_exp_f32 v123, v123
  v_pk_add_f32 v[128:129], v[128:129], v[220:221] op_sel_hi:[1,0] neg_lo:[0,1] neg_hi:[0,1]
  v_pk_add_f32 v[130:131], v[130:131], v[220:221] op_sel_hi:[1,0] neg_lo:[0,1] neg_hi:[0,1]
  v_cvt_pk_bf16_f32 v178, v116, v117
  v_cvt_pk_bf16_f32 v179, v118, v119
  v_mfma_f32_16x16x32_bf16 v[56:59], a[24:27], a[184:187], 0
  ds_read_b128 a[108:111], v243 offset:1024
  v_exp_f32 v124, v124
  v_exp_f32 v125, v125
  v_exp_f32 v126, v126
  v_exp_f32 v127, v127
  v_pk_add_f32 v[132:133], v[132:133], v[220:221] op_sel_hi:[1,0] neg_lo:[0,1] neg_hi:[0,1]
  v_pk_add_f32 v[134:135], v[134:135], v[220:221] op_sel_hi:[1,0] neg_lo:[0,1] neg_hi:[0,1]
  v_cvt_pk_bf16_f32 v180, v120, v121
  v_cvt_pk_bf16_f32 v181, v122, v123
  v_mfma_f32_16x16x32_bf16 v[60:63], a[28:31], a[184:187], 0
  ds_read_b128 a[112:115], v243 offset:4096
  v_exp_f32 v128, v128
  v_exp_f32 v129, v129
  v_exp_f32 v130, v130
  v_exp_f32 v131, v131
  v_pk_add_f32 v[136:137], v[136:137], v[220:221] op_sel_hi:[1,0] neg_lo:[0,1] neg_hi:[0,1]
  v_pk_add_f32 v[138:139], v[138:139], v[220:221] op_sel_hi:[1,0] neg_lo:[0,1] neg_hi:[0,1]
  v_cvt_pk_bf16_f32 v182, v124, v125
  v_cvt_pk_bf16_f32 v183, v126, v127
  s_waitcnt lgkmcnt(8)
  v_mfma_f32_16x16x32_bf16 v[64:67], a[32:35], a[184:187], 0
  ds_read_b128 a[116:119], v243 offset:7168
  v_exp_f32 v132, v132
  v_exp_f32 v133, v133
  v_exp_f32 v134, v134
  v_exp_f32 v135, v135
  v_pk_add_f32 v[140:141], v[140:141], v[220:221] op_sel_hi:[1,0] neg_lo:[0,1] neg_hi:[0,1]
  v_pk_add_f32 v[142:143], v[142:143], v[220:221] op_sel_hi:[1,0] neg_lo:[0,1] neg_hi:[0,1]
  v_cvt_pk_bf16_f32 v184, v128, v129
  v_cvt_pk_bf16_f32 v185, v130, v131
  v_mfma_f32_16x16x32_bf16 v[68:71], a[36:39], a[184:187], 0
  ds_read_b128 a[120:123], v243 offset:10240
  v_exp_f32 v136, v136
  v_exp_f32 v137, v137
  v_exp_f32 v138, v138
  v_exp_f32 v139, v139
  v_pk_add_f32 v[144:145], v[144:145], v[220:221] op_sel_hi:[1,0] neg_lo:[0,1] neg_hi:[0,1]
  v_pk_add_f32 v[146:147], v[146:147], v[220:221] op_sel_hi:[1,0] neg_lo:[0,1] neg_hi:[0,1]
  v_cvt_pk_bf16_f32 v186, v132, v133
  v_cvt_pk_bf16_f32 v187, v134, v135
  v_mfma_f32_16x16x32_bf16 v[72:75], a[40:43], a[184:187], 0
  ds_read_b128 a[124:127], v243 offset:13312
  v_exp_f32 v140, v140
  v_exp_f32 v141, v141
  v_exp_f32 v142, v142
  v_exp_f32 v143, v143
  v_pk_add_f32 v[148:149], v[148:149], v[220:221] op_sel_hi:[1,0] neg_lo:[0,1] neg_hi:[0,1]
  v_pk_add_f32 v[150:151], v[150:151], v[220:221] op_sel_hi:[1,0] neg_lo:[0,1] neg_hi:[0,1]
  v_cvt_pk_bf16_f32 v188, v136, v137
  v_cvt_pk_bf16_f32 v189, v138, v139
  v_mfma_f32_16x16x32_bf16 v[76:79], a[44:47], a[184:187], 0
  ds_read_b128 a[128:131], v243 offset:16384
  v_exp_f32 v144, v144
  v_exp_f32 v145, v145
  v_exp_f32 v146, v146
  v_exp_f32 v147, v147
  v_pk_add_f32 v[152:153], v[152:153], v[220:221] op_sel_hi:[1,0] neg_lo:[0,1] neg_hi:[0,1]
  v_pk_add_f32 v[154:155], v[154:155], v[220:221] op_sel_hi:[1,0] neg_lo:[0,1] neg_hi:[0,1]
  v_cvt_pk_bf16_f32 v190, v140, v141
  v_cvt_pk_bf16_f32 v191, v142, v143
  s_waitcnt lgkmcnt(8)
  v_mfma_f32_16x16x32_bf16 v[80:83], a[48:51], a[184:187], 0
  ds_read_b128 a[132:135], v243 offset:19456
  v_exp_f32 v148, v148
  v_exp_f32 v149, v149
  v_exp_f32 v150, v150
  v_exp_f32 v151, v151
  v_pk_add_f32 v[156:157], v[156:157], v[220:221] op_sel_hi:[1,0] neg_lo:[0,1] neg_hi:[0,1]
  v_pk_add_f32 v[158:159], v[158:159], v[220:221] op_sel_hi:[1,0] neg_lo:[0,1] neg_hi:[0,1]
  v_cvt_pk_bf16_f32 v192, v144, v145
  v_cvt_pk_bf16_f32 v193, v146, v147
  v_mfma_f32_16x16x32_bf16 v[84:87], a[52:55], a[184:187], 0
  ds_read_b128 a[136:139], v243 offset:22528
  v_exp_f32 v152, v152
  v_exp_f32 v153, v153
  v_exp_f32 v154, v154
  v_exp_f32 v155, v155
  v_pk_add_f32 v[160:161], v[160:161], v[220:221] op_sel_hi:[1,0] neg_lo:[0,1] neg_hi:[0,1]
  v_pk_add_f32 v[162:163], v[162:163], v[220:221] op_sel_hi:[1,0] neg_lo:[0,1] neg_hi:[0,1]
  v_cvt_pk_bf16_f32 v194, v148, v149
  v_cvt_pk_bf16_f32 v195, v150, v151
  v_mfma_f32_16x16x32_bf16 v[88:91], a[56:59], a[184:187], 0
  ds_read_b128 a[140:143], v243 offset:25600
  v_exp_f32 v156, v156
  v_exp_f32 v157, v157
  v_exp_f32 v158, v158
  v_exp_f32 v159, v159
  v_pk_add_f32 v[164:165], v[164:165], v[220:221] op_sel_hi:[1,0] neg_lo:[0,1] neg_hi:[0,1]
  v_pk_add_f32 v[166:167], v[166:167], v[220:221] op_sel_hi:[1,0] neg_lo:[0,1] neg_hi:[0,1]
  v_cvt_pk_bf16_f32 v196, v152, v153
  v_cvt_pk_bf16_f32 v197, v154, v155
  v_mfma_f32_16x16x32_bf16 v[92:95], a[60:63], a[184:187], 0
  v_exp_f32 v160, v160
  v_exp_f32 v161, v161
  v_exp_f32 v162, v162
  v_exp_f32 v163, v163
  v_cvt_pk_bf16_f32 v198, v156, v157
  v_cvt_pk_bf16_f32 v199, v158, v159
  s_waitcnt lgkmcnt(9)
  v_mfma_f32_16x16x32_bf16 v[96:99], a[64:67], a[184:187], v[212:215]
  v_exp_f32 v164, v164
  v_exp_f32 v165, v165
  v_exp_f32 v166, v166
  v_exp_f32 v167, v167
  v_cvt_pk_bf16_f32 v200, v160, v161
  v_cvt_pk_bf16_f32 v201, v162, v163
  v_cvt_pk_bf16_f32 v202, v164, v165
  v_cvt_pk_bf16_f32 v203, v166, v167
  v_mov_b32 v168, 0
  v_mov_b32 v169, 0
  v_max3_f32 v222, v32, v33, v34
  s_nop 0
  v_mfma_f32_16x16x32_bf16 v[204:207], a[72:75], v[168:171], 0
  v_max3_f32 v223, v49, v50, v51
  v_max3_f32 v224, v66, v67, v68
  v_mfma_f32_16x16x32_bf16 v[208:211], a[144:147], v[168:171], 0
  v_max3_f32 v225, v83, v84, v85
  v_max3_f32 v222, v222, v35, v36
  v_mfma_f32_16x16x32_bf16 v[204:207], a[76:79], v[172:175], v[204:207]
  v_max3_f32 v223, v223, v52, v53
  v_max3_f32 v224, v224, v69, v70
  v_mfma_f32_16x16x32_bf16 v[208:211], a[148:151], v[172:175], v[208:211]
  v_max3_f32 v225, v225, v86, v87
  v_max3_f32 v222, v222, v37, v38
  v_mfma_f32_16x16x32_bf16 v[204:207], a[80:83], v[176:179], v[204:207]
  v_max3_f32 v223, v223, v54, v55
  v_max3_f32 v224, v224, v71, v72
  v_max3_f32 v225, v225, v88, v89
  v_mfma_f32_16x16x32_bf16 v[208:211], a[152:155], v[176:179], v[208:211]
  v_max3_f32 v222, v222, v39, v40
  v_max3_f32 v223, v223, v56, v57
  v_mfma_f32_16x16x32_bf16 v[204:207], a[84:87], v[180:183], v[204:207]
  v_max3_f32 v224, v224, v73, v74
  v_max3_f32 v225, v225, v90, v91
  v_mfma_f32_16x16x32_bf16 v[208:211], a[156:159], v[180:183], v[208:211]
  v_max3_f32 v222, v222, v41, v42
  v_max3_f32 v223, v223, v58, v59
  v_mfma_f32_16x16x32_bf16 v[204:207], a[88:91], v[184:187], v[204:207]
  v_max3_f32 v224, v224, v75, v76
  v_max3_f32 v225, v225, v92, v93
  v_max3_f32 v222, v222, v43, v44
  v_mfma_f32_16x16x32_bf16 v[208:211], a[160:163], v[184:187], v[208:211]
  v_max3_f32 v223, v223, v60, v61
  v_max3_f32 v224, v224, v77, v78
  v_mfma_f32_16x16x32_bf16 v[204:207], a[92:95], v[188:191], v[204:207]
  v_max3_f32 v225, v225, v94, v95
  v_max3_f32 v222, v222, v45, v46
  v_mfma_f32_16x16x32_bf16 v[208:211], a[164:167], v[188:191], v[208:211]
  v_max3_f32 v223, v223, v62, v63
  v_max3_f32 v224, v224, v79, v80
  v_mfma_f32_16x16x32_bf16 v[204:207], a[96:99], v[192:195], v[204:207]
  v_max3_f32 v225, v225, v96, v97
  v_max3_f32 v222, v222, v47, v48
  v_mfma_f32_16x16x32_bf16 v[208:211], a[168:171], v[192:195], v[208:211]
  v_max3_f32 v223, v223, v64, v65
  v_max3_f32 v224, v224, v81, v82
  v_max3_f32 v225, v225, v98, v99
  v_mfma_f32_16x16x32_bf16 v[204:207], a[100:103], v[196:199], v[204:207]
  v_max3_f32 v220, v222, v223, v224
  v_max_f32 v220, v220, v225
  v_mfma_f32_16x16x32_bf16 v[208:211], a[172:175], v[196:199], v[208:211]
  v_mov_b32 v226, v220
  s_nop 1
  v_permlane32_swap_b32 v220, v226
  v_mfma_f32_16x16x32_bf16 v[204:207], a[104:107], v[200:203], v[204:207]
  v_max_f32 v220, v220, v226
  v_mov_b32 v226, v220
  v_mfma_f32_16x16x32_bf16 v[208:211], a[176:179], v[200:203], v[208:211]
  s_nop 0
  v_permlane16_swap_b32 v220, v226
  v_max_f32 v220, v220, v226
  v_pk_add_f32 v[32:33], v[32:33], v[220:221] op_sel_hi:[1,0] neg_lo:[0,1] neg_hi:[0,1]
  v_pk_add_f32 v[34:35], v[34:35], v[220:221] op_sel_hi:[1,0] neg_lo:[0,1] neg_hi:[0,1]
  v_pk_add_f32 v[36:37], v[36:37], v[220:221] op_sel_hi:[1,0] neg_lo:[0,1] neg_hi:[0,1]
  v_pk_add_f32 v[38:39], v[38:39], v[220:221] op_sel_hi:[1,0] neg_lo:[0,1] neg_hi:[0,1]
  v_mfma_f32_16x16x32_bf16 v[100:103], a[4:7], a[192:195], v[216:219]
  v_exp_f32 v32, v32
  v_exp_f32 v33, v33
  v_exp_f32 v34, v34
  v_exp_f32 v35, v35
  v_pk_add_f32 v[40:41], v[40:41], v[220:221] op_sel_hi:[1,0] neg_lo:[0,1] neg_hi:[0,1]
  v_pk_add_f32 v[42:43], v[42:43], v[220:221] op_sel_hi:[1,0] neg_lo:[0,1] neg_hi:[0,1]
  v_mfma_f32_16x16x32_bf16 v[104:107], a[8:11], a[192:195], 0
  v_exp_f32 v36, v36
  v_exp_f32 v37, v37
  v_exp_f32 v38, v38
  v_exp_f32 v39, v39
  v_pk_add_f32 v[44:45], v[44:45], v[220:221] op_sel_hi:[1,0] neg_lo:[0,1] neg_hi:[0,1]
  v_pk_add_f32 v[46:47], v[46:47], v[220:221] op_sel_hi:[1,0] neg_lo:[0,1] neg_hi:[0,1]
  v_cvt_pk_bf16_f32 v168, v32, v33
  v_cvt_pk_bf16_f32 v169, v34, v35
  v_mov_b32 v226, v208
  v_mov_b32 v227, v208
  s_nop 1
  v_permlane32_swap_b32 v227, v226
  v_rcp_f32 v226, v226
  s_nop 0
  v_pk_mul_f32 v[204:205], v[204:205], v[226:227] op_sel_hi:[1,0]
  v_pk_mul_f32 v[208:209], v[208:209], v[226:227] op_sel_hi:[1,0]
  v_pk_mul_f32 v[206:207], v[206:207], v[226:227] op_sel_hi:[1,0]
  v_pk_mul_f32 v[210:211], v[210:211], v[226:227] op_sel_hi:[1,0]
  v_cvt_pk_bf16_f32 v234, v204, v205
  v_cvt_pk_bf16_f32 v235, v206, v207
  v_cvt_pk_bf16_f32 v240, v208, v209
  v_cvt_pk_bf16_f32 v241, v210, v211
  v_mfma_f32_16x16x32_bf16 v[108:111], a[12:15], a[192:195], 0
  s_mul_i32 s35, s3, 13
  s_min_u32 s35, s35, 37
  s_lshl_b32 s35, s35, 10
  s_add_u32 s34, s33, s35
  s_add_u32 s35, s35, 102400
  s_mov_b32 m0, s35
  s_nop 0
  buffer_load_dwordx4 v2, s[8:11], s34 offen offset:0 lds
  v_exp_f32 v40, v40
  v_exp_f32 v41, v41
  v_exp_f32 v42, v42
  v_exp_f32 v43, v43
  v_pk_add_f32 v[48:49], v[48:49], v[220:221] op_sel_hi:[1,0] neg_lo:[0,1] neg_hi:[0,1]
  v_pk_add_f32 v[50:51], v[50:51], v[220:221] op_sel_hi:[1,0] neg_lo:[0,1] neg_hi:[0,1]
  v_cvt_pk_bf16_f32 v170, v36, v37
  v_cvt_pk_bf16_f32 v171, v38, v39
  v_mfma_f32_16x16x32_bf16 v[112:115], a[16:19], a[192:195], 0
  buffer_load_dwordx4 v2, s[8:11], s34 offen offset:1024 lds
  v_exp_f32 v44, v44
  v_exp_f32 v45, v45
  v_exp_f32 v46, v46
  v_exp_f32 v47, v47
  v_pk_add_f32 v[52:53], v[52:53], v[220:221] op_sel_hi:[1,0] neg_lo:[0,1] neg_hi:[0,1]
  v_pk_add_f32 v[54:55], v[54:55], v[220:221] op_sel_hi:[1,0] neg_lo:[0,1] neg_hi:[0,1]
  v_cvt_pk_bf16_f32 v172, v40, v41
  v_cvt_pk_bf16_f32 v173, v42, v43
  v_mfma_f32_16x16x32_bf16 v[116:119], a[20:23], a[192:195], 0
  buffer_load_dwordx4 v2, s[8:11], s34 offen offset:2048 lds
  v_exp_f32 v48, v48
  v_exp_f32 v49, v49
  v_exp_f32 v50, v50
  v_exp_f32 v51, v51
  v_pk_add_f32 v[56:57], v[56:57], v[220:221] op_sel_hi:[1,0] neg_lo:[0,1] neg_hi:[0,1]
  v_pk_add_f32 v[58:59], v[58:59], v[220:221] op_sel_hi:[1,0] neg_lo:[0,1] neg_hi:[0,1]
  v_cvt_pk_bf16_f32 v174, v44, v45
  v_cvt_pk_bf16_f32 v175, v46, v47
  v_mfma_f32_16x16x32_bf16 v[120:123], a[24:27], a[192:195], 0
  buffer_load_dwordx4 v2, s[8:11], s34 offen offset:3072 lds
  v_exp_f32 v52, v52
  v_exp_f32 v53, v53
  v_exp_f32 v54, v54
  v_exp_f32 v55, v55
  v_pk_add_f32 v[60:61], v[60:61], v[220:221] op_sel_hi:[1,0] neg_lo:[0,1] neg_hi:[0,1]
  v_pk_add_f32 v[62:63], v[62:63], v[220:221] op_sel_hi:[1,0] neg_lo:[0,1] neg_hi:[0,1]
  v_cvt_pk_bf16_f32 v176, v48, v49
  v_cvt_pk_bf16_f32 v177, v50, v51
  v_mfma_f32_16x16x32_bf16 v[124:127], a[28:31], a[192:195], 0
  s_add_u32 s35, s35, 4096
  s_add_u32 s34, s34, 4096
  s_mov_b32 m0, s35
  s_nop 0
  buffer_load_dwordx4 v2, s[8:11], s34 offen offset:0 lds
  v_exp_f32 v56, v56
  v_exp_f32 v57, v57
  v_exp_f32 v58, v58
  v_exp_f32 v59, v59
  v_pk_add_f32 v[64:65], v[64:65], v[220:221] op_sel_hi:[1,0] neg_lo:[0,1] neg_hi:[0,1]
  v_pk_add_f32 v[66:67], v[66:67], v[220:221] op_sel_hi:[1,0] neg_lo:[0,1] neg_hi:[0,1]
  v_cvt_pk_bf16_f32 v178, v52, v53
  v_cvt_pk_bf16_f32 v179, v54, v55
  v_mfma_f32_16x16x32_bf16 v[128:131], a[32:35], a[192:195], 0
  buffer_load_dwordx4 v2, s[8:11], s34 offen offset:1024 lds
  v_exp_f32 v60, v60
  v_exp_f32 v61, v61
  v_exp_f32 v62, v62
  v_exp_f32 v63, v63
  v_pk_add_f32 v[68:69], v[68:69], v[220:221] op_sel_hi:[1,0] neg_lo:[0,1] neg_hi:[0,1]
  v_pk_add_f32 v[70:71], v[70:71], v[220:221] op_sel_hi:[1,0] neg_lo:[0,1] neg_hi:[0,1]
  v_cvt_pk_bf16_f32 v180, v56, v57
  v_cvt_pk_bf16_f32 v181, v58, v59
  v_mfma_f32_16x16x32_bf16 v[132:135], a[36:39], a[192:195], 0
  buffer_load_dwordx4 v2, s[8:11], s34 offen offset:2048 lds
  v_exp_f32 v64, v64
  v_exp_f32 v65, v65
  v_exp_f32 v66, v66
  v_exp_f32 v67, v67
  v_pk_add_f32 v[72:73], v[72:73], v[220:221] op_sel_hi:[1,0] neg_lo:[0,1] neg_hi:[0,1]
  v_pk_add_f32 v[74:75], v[74:75], v[220:221] op_sel_hi:[1,0] neg_lo:[0,1] neg_hi:[0,1]
  v_cvt_pk_bf16_f32 v182, v60, v61
  v_cvt_pk_bf16_f32 v183, v62, v63
  v_mfma_f32_16x16x32_bf16 v[136:139], a[40:43], a[192:195], 0
  buffer_load_dwordx4 v2, s[8:11], s34 offen offset:3072 lds
  v_exp_f32 v68, v68
  v_exp_f32 v69, v69
  v_exp_f32 v70, v70
  v_exp_f32 v71, v71
  v_pk_add_f32 v[76:77], v[76:77], v[220:221] op_sel_hi:[1,0] neg_lo:[0,1] neg_hi:[0,1]
  v_pk_add_f32 v[78:79], v[78:79], v[220:221] op_sel_hi:[1,0] neg_lo:[0,1] neg_hi:[0,1]
  v_cvt_pk_bf16_f32 v184, v64, v65
  v_cvt_pk_bf16_f32 v185, v66, v67
  v_mfma_f32_16x16x32_bf16 v[140:143], a[44:47], a[192:195], 0
  s_add_u32 s35, s35, 4096
  s_add_u32 s34, s34, 4096
  s_mov_b32 m0, s35
  s_nop 0
  buffer_load_dwordx4 v2, s[8:11], s34 offen offset:0 lds
  v_exp_f32 v72, v72
  v_exp_f32 v73, v73
  v_exp_f32 v74, v74
  v_exp_f32 v75, v75
  v_pk_add_f32 v[80:81], v[80:81], v[220:221] op_sel_hi:[1,0] neg_lo:[0,1] neg_hi:[0,1]
  v_pk_add_f32 v[82:83], v[82:83], v[220:221] op_sel_hi:[1,0] neg_lo:[0,1] neg_hi:[0,1]
  v_cvt_pk_bf16_f32 v186, v68, v69
  v_cvt_pk_bf16_f32 v187, v70, v71
  v_mfma_f32_16x16x32_bf16 v[144:147], a[48:51], a[192:195], 0
  buffer_load_dwordx4 v2, s[8:11], s34 offen offset:1024 lds
  v_exp_f32 v76, v76
  v_exp_f32 v77, v77
  v_exp_f32 v78, v78
  v_exp_f32 v79, v79
  v_pk_add_f32 v[84:85], v[84:85], v[220:221] op_sel_hi:[1,0] neg_lo:[0,1] neg_hi:[0,1]
  v_pk_add_f32 v[86:87], v[86:87], v[220:221] op_sel_hi:[1,0] neg_lo:[0,1] neg_hi:[0,1]
  v_cvt_pk_bf16_f32 v188, v72, v73
  v_cvt_pk_bf16_f32 v189, v74, v75
  v_mfma_f32_16x16x32_bf16 v[148:151], a[52:55], a[192:195], 0
  buffer_load_dwordx4 v2, s[8:11], s34 offen offset:2048 lds
  v_exp_f32 v80, v80
  v_exp_f32 v81, v81
  v_exp_f32 v82, v82
  v_exp_f32 v83, v83
  v_pk_add_f32 v[88:89], v[88:89], v[220:221] op_sel_hi:[1,0] neg_lo:[0,1] neg_hi:[0,1]
  v_pk_add_f32 v[90:91], v[90:91], v[220:221] op_sel_hi:[1,0] neg_lo:[0,1] neg_hi:[0,1]
  v_cvt_pk_bf16_f32 v190, v76, v77
  v_cvt_pk_bf16_f32 v191, v78, v79
  v_mfma_f32_16x16x32_bf16 v[152:155], a[56:59], a[192:195], 0
  buffer_load_dwordx4 v2, s[8:11], s34 offen offset:3072 lds
  v_exp_f32 v84, v84
  v_exp_f32 v85, v85
  v_exp_f32 v86, v86
  v_exp_f32 v87, v87
  v_pk_add_f32 v[92:93], v[92:93], v[220:221] op_sel_hi:[1,0] neg_lo:[0,1] neg_hi:[0,1]
  v_pk_add_f32 v[94:95], v[94:95], v[220:221] op_sel_hi:[1,0] neg_lo:[0,1] neg_hi:[0,1]
  v_cvt_pk_bf16_f32 v192, v80, v81
  v_cvt_pk_bf16_f32 v193, v82, v83
  v_mfma_f32_16x16x32_bf16 v[156:159], a[60:63], a[192:195], 0
  s_add_u32 s35, s35, 4096
  s_add_u32 s34, s34, 4096
  s_mov_b32 m0, s35
  s_nop 0
  buffer_load_dwordx4 v2, s[8:11], s34 offen offset:0 lds
  v_exp_f32 v88, v88
  v_exp_f32 v89, v89
  v_exp_f32 v90, v90
  v_exp_f32 v91, v91
  v_pk_add_f32 v[96:97], v[96:97], v[220:221] op_sel_hi:[1,0] neg_lo:[0,1] neg_hi:[0,1]
  v_pk_add_f32 v[98:99], v[98:99], v[220:221] op_sel_hi:[1,0] neg_lo:[0,1] neg_hi:[0,1]
  v_cvt_pk_bf16_f32 v194, v84, v85
  v_cvt_pk_bf16_f32 v195, v86, v87
  v_mfma_f32_16x16x32_bf16 v[160:163], a[64:67], a[192:195], 0
  v_exp_f32 v92, v92
  v_exp_f32 v93, v93
  v_exp_f32 v94, v94
  v_exp_f32 v95, v95
  v_cvt_pk_bf16_f32 v196, v88, v89
  v_cvt_pk_bf16_f32 v197, v90, v91
  v_mfma_f32_16x16x32_bf16 v[164:167], a[68:71], a[192:195], v[212:215]
  v_exp_f32 v96, v96
  v_exp_f32 v97, v97
  v_exp_f32 v98, v98
  v_exp_f32 v99, v99
  v_cvt_pk_bf16_f32 v198, v92, v93
  v_cvt_pk_bf16_f32 v199, v94, v95
  v_cvt_pk_bf16_f32 v200, v96, v97
  v_cvt_pk_bf16_f32 v201, v98, v99
  v_mov_b32 v202, 0
  v_mov_b32 v203, 0
  v_max3_f32 v222, v100, v101, v102
  s_waitcnt lgkmcnt(8)
  v_mfma_f32_16x16x32_bf16 v[204:207], a[108:111], v[168:171], 0
  v_max3_f32 v223, v117, v118, v119
  v_max3_f32 v224, v134, v135, v136
  v_mfma_f32_16x16x32_bf16 v[208:211], a[144:147], v[168:171], 0
  v_max3_f32 v225, v151, v152, v153
  v_max3_f32 v222, v222, v103, v104
  s_waitcnt lgkmcnt(7)
  v_mfma_f32_16x16x32_bf16 v[204:207], a[112:115], v[172:175], v[204:207]
  v_max3_f32 v223, v223, v120, v121
  v_max3_f32 v224, v224, v137, v138
  v_mfma_f32_16x16x32_bf16 v[208:211], a[148:151], v[172:175], v[208:211]
  v_max3_f32 v225, v225, v154, v155
  v_max3_f32 v222, v222, v105, v106
  s_waitcnt lgkmcnt(6)
  v_mfma_f32_16x16x32_bf16 v[204:207], a[116:119], v[176:179], v[204:207]
  v_max3_f32 v223, v223, v122, v123
  v_max3_f32 v224, v224, v139, v140
  v_max3_f32 v225, v225, v156, v157
  v_mfma_f32_16x16x32_bf16 v[208:211], a[152:155], v[176:179], v[208:211]
  v_max3_f32 v222, v222, v107, v108
  v_max3_f32 v223, v223, v124, v125
  s_waitcnt lgkmcnt(5)
  v_mfma_f32_16x16x32_bf16 v[204:207], a[120:123], v[180:183], v[204:207]
  v_max3_f32 v224, v224, v141, v142
  v_max3_f32 v225, v225, v158, v159
  v_mfma_f32_16x16x32_bf16 v[208:211], a[156:159], v[180:183], v[208:211]
  v_max3_f32 v222, v222, v109, v110
  v_max3_f32 v223, v223, v126, v127
  s_waitcnt lgkmcnt(4)
  v_mfma_f32_16x16x32_bf16 v[204:207], a[124:127], v[184:187], v[204:207]
  v_max3_f32 v224, v224, v143, v144
  v_max3_f32 v225, v225, v160, v161
  v_max3_f32 v222, v222, v111, v112
  v_mfma_f32_16x16x32_bf16 v[208:211], a[160:163], v[184:187], v[208:211]
  v_max3_f32 v223, v223, v128, v129
  v_max3_f32 v224, v224, v145, v146
  s_waitcnt lgkmcnt(3)
  v_mfma_f32_16x16x32_bf16 v[204:207], a[128:131], v[188:191], v[204:207]
  v_max3_f32 v225, v225, v162, v163
  v_max3_f32 v222, v222, v113, v114
  v_mfma_f32_16x16x32_bf16 v[208:211], a[164:167], v[188:191], v[208:211]
  v_max3_f32 v223, v223, v130, v131
  v_max3_f32 v224, v224, v147, v148
  s_waitcnt lgkmcnt(2)
  v_mfma_f32_16x16x32_bf16 v[204:207], a[132:135], v[192:195], v[204:207]
  v_max3_f32 v225, v225, v164, v165
  v_max3_f32 v222, v222, v115, v116
  v_mfma_f32_16x16x32_bf16 v[208:211], a[168:171], v[192:195], v[208:211]
  v_max3_f32 v223, v223, v132, v133
  v_max3_f32 v224, v224, v149, v150
  v_max3_f32 v225, v225, v166, v167
  s_waitcnt lgkmcnt(1)
  v_mfma_f32_16x16x32_bf16 v[204:207], a[136:139], v[196:199], v[204:207]
  v_max3_f32 v220, v222, v223, v224
  v_max_f32 v220, v220, v225
  v_mfma_f32_16x16x32_bf16 v[208:211], a[172:175], v[196:199], v[208:211]
  v_mov_b32 v226, v220
  s_nop 1
  v_permlane32_swap_b32 v220, v226
  s_waitcnt lgkmcnt(0)
  v_mfma_f32_16x16x32_bf16 v[204:207], a[140:143], v[200:203], v[204:207]
  v_max_f32 v220, v220, v226
  v_mov_b32 v226, v220
  v_mfma_f32_16x16x32_bf16 v[208:211], a[176:179], v[200:203], v[208:211]
  s_nop 0
  v_permlane16_swap_b32 v220, v226
  v_max_f32 v220, v220, v226
  v_pk_add_f32 v[100:101], v[100:101], v[220:221] op_sel_hi:[1,0] neg_lo:[0,1] neg_hi:[0,1]
  v_pk_add_f32 v[102:103], v[102:103], v[220:221] op_sel_hi:[1,0] neg_lo:[0,1] neg_hi:[0,1]
  v_pk_add_f32 v[104:105], v[104:105], v[220:221] op_sel_hi:[1,0] neg_lo:[0,1] neg_hi:[0,1]
  v_pk_add_f32 v[106:107], v[106:107], v[220:221] op_sel_hi:[1,0] neg_lo:[0,1] neg_hi:[0,1]
  v_exp_f32 v100, v100
  v_exp_f32 v101, v101
  v_exp_f32 v102, v102
  v_exp_f32 v103, v103
  v_pk_add_f32 v[108:109], v[108:109], v[220:221] op_sel_hi:[1,0] neg_lo:[0,1] neg_hi:[0,1]
  v_pk_add_f32 v[110:111], v[110:111], v[220:221] op_sel_hi:[1,0] neg_lo:[0,1] neg_hi:[0,1]
  v_exp_f32 v104, v104
  v_exp_f32 v105, v105
  v_exp_f32 v106, v106
  v_exp_f32 v107, v107
  v_pk_add_f32 v[112:113], v[112:113], v[220:221] op_sel_hi:[1,0] neg_lo:[0,1] neg_hi:[0,1]
  v_pk_add_f32 v[114:115], v[114:115], v[220:221] op_sel_hi:[1,0] neg_lo:[0,1] neg_hi:[0,1]
  v_cvt_pk_bf16_f32 v170, v100, v101
  v_cvt_pk_bf16_f32 v171, v102, v103
  v_mov_b32 v226, v208
  v_mov_b32 v227, v208
  s_nop 1
  v_permlane32_swap_b32 v227, v226
  v_rcp_f32 v226, v226
  s_nop 0
  v_pk_mul_f32 v[204:205], v[204:205], v[226:227] op_sel_hi:[1,0]
  v_pk_mul_f32 v[208:209], v[208:209], v[226:227] op_sel_hi:[1,0]
  v_pk_mul_f32 v[206:207], v[206:207], v[226:227] op_sel_hi:[1,0]
  v_pk_mul_f32 v[210:211], v[210:211], v[226:227] op_sel_hi:[1,0]
  v_cvt_pk_bf16_f32 v232, v204, v205
  v_cvt_pk_bf16_f32 v233, v206, v207
  v_cvt_pk_bf16_f32 v228, v208, v209
  v_cvt_pk_bf16_f32 v229, v210, v211
  v_cndmask_b32_e64 v238, v238, v228, s[44:45]
  v_cndmask_b32_e64 v239, v239, v229, s[44:45]
  v_exp_f32 v108, v108
  v_exp_f32 v109, v109
  v_exp_f32 v110, v110
  v_exp_f32 v111, v111
  v_pk_add_f32 v[116:117], v[116:117], v[220:221] op_sel_hi:[1,0] neg_lo:[0,1] neg_hi:[0,1]
  v_pk_add_f32 v[118:119], v[118:119], v[220:221] op_sel_hi:[1,0] neg_lo:[0,1] neg_hi:[0,1]
  v_cvt_pk_bf16_f32 v172, v104, v105
  v_cvt_pk_bf16_f32 v173, v106, v107
  v_exp_f32 v112, v112
  v_exp_f32 v113, v113
  v_exp_f32 v114, v114
  v_exp_f32 v115, v115
  v_pk_add_f32 v[120:121], v[120:121], v[220:221] op_sel_hi:[1,0] neg_lo:[0,1] neg_hi:[0,1]
  v_pk_add_f32 v[122:123], v[122:123], v[220:221] op_sel_hi:[1,0] neg_lo:[0,1] neg_hi:[0,1]
  v_cvt_pk_bf16_f32 v174, v108, v109
  v_cvt_pk_bf16_f32 v175, v110, v111
  v_exp_f32 v116, v116
  v_exp_f32 v117, v117
  v_exp_f32 v118, v118
  v_exp_f32 v119, v119
  v_pk_add_f32 v[124:125], v[124:125], v[220:221] op_sel_hi:[1,0] neg_lo:[0,1] neg_hi:[0,1]
  v_pk_add_f32 v[126:127], v[126:127], v[220:221] op_sel_hi:[1,0] neg_lo:[0,1] neg_hi:[0,1]
  v_cvt_pk_bf16_f32 v176, v112, v113
  v_cvt_pk_bf16_f32 v177, v114, v115
  v_exp_f32 v120, v120
  v_exp_f32 v121, v121
  v_exp_f32 v122, v122
  v_exp_f32 v123, v123
  v_pk_add_f32 v[128:129], v[128:129], v[220:221] op_sel_hi:[1,0] neg_lo:[0,1] neg_hi:[0,1]
  v_pk_add_f32 v[130:131], v[130:131], v[220:221] op_sel_hi:[1,0] neg_lo:[0,1] neg_hi:[0,1]
  v_cvt_pk_bf16_f32 v178, v116, v117
  v_cvt_pk_bf16_f32 v179, v118, v119
  v_exp_f32 v124, v124
  v_exp_f32 v125, v125
  v_exp_f32 v126, v126
  v_exp_f32 v127, v127
  v_pk_add_f32 v[132:133], v[132:133], v[220:221] op_sel_hi:[1,0] neg_lo:[0,1] neg_hi:[0,1]
  v_pk_add_f32 v[134:135], v[134:135], v[220:221] op_sel_hi:[1,0] neg_lo:[0,1] neg_hi:[0,1]
  v_cvt_pk_bf16_f32 v180, v120, v121
  v_cvt_pk_bf16_f32 v181, v122, v123
  v_exp_f32 v128, v128
  v_exp_f32 v129, v129
  v_exp_f32 v130, v130
  v_exp_f32 v131, v131
  v_pk_add_f32 v[136:137], v[136:137], v[220:221] op_sel_hi:[1,0] neg_lo:[0,1] neg_hi:[0,1]
  v_pk_add_f32 v[138:139], v[138:139], v[220:221] op_sel_hi:[1,0] neg_lo:[0,1] neg_hi:[0,1]
  v_cvt_pk_bf16_f32 v182, v124, v125
  v_cvt_pk_bf16_f32 v183, v126, v127
  v_exp_f32 v132, v132
  v_exp_f32 v133, v133
  v_exp_f32 v134, v134
  v_exp_f32 v135, v135
  v_pk_add_f32 v[140:141], v[140:141], v[220:221] op_sel_hi:[1,0] neg_lo:[0,1] neg_hi:[0,1]
  v_pk_add_f32 v[142:143], v[142:143], v[220:221] op_sel_hi:[1,0] neg_lo:[0,1] neg_hi:[0,1]
  v_cvt_pk_bf16_f32 v184, v128, v129
  v_cvt_pk_bf16_f32 v185, v130, v131
  v_exp_f32 v136, v136
  v_exp_f32 v137, v137
  v_exp_f32 v138, v138
  v_exp_f32 v139, v139
  v_pk_add_f32 v[144:145], v[144:145], v[220:221] op_sel_hi:[1,0] neg_lo:[0,1] neg_hi:[0,1]
  v_pk_add_f32 v[146:147], v[146:147], v[220:221] op_sel_hi:[1,0] neg_lo:[0,1] neg_hi:[0,1]
  v_cvt_pk_bf16_f32 v186, v132, v133
  v_cvt_pk_bf16_f32 v187, v134, v135
  v_exp_f32 v140, v140
  v_exp_f32 v141, v141
  v_exp_f32 v142, v142
  v_exp_f32 v143, v143
  v_pk_add_f32 v[148:149], v[148:149], v[220:221] op_sel_hi:[1,0] neg_lo:[0,1] neg_hi:[0,1]
  v_pk_add_f32 v[150:151], v[150:151], v[220:221] op_sel_hi:[1,0] neg_lo:[0,1] neg_hi:[0,1]
  v_cvt_pk_bf16_f32 v188, v136, v137
  v_cvt_pk_bf16_f32 v189, v138, v139
  v_exp_f32 v144, v144
  v_exp_f32 v145, v145
  v_exp_f32 v146, v146
  v_exp_f32 v147, v147
  v_pk_add_f32 v[152:153], v[152:153], v[220:221] op_sel_hi:[1,0] neg_lo:[0,1] neg_hi:[0,1]
  v_pk_add_f32 v[154:155], v[154:155], v[220:221] op_sel_hi:[1,0] neg_lo:[0,1] neg_hi:[0,1]
  v_cvt_pk_bf16_f32 v190, v140, v141
  v_cvt_pk_bf16_f32 v191, v142, v143
  v_exp_f32 v148, v148
  v_exp_f32 v149, v149
  v_exp_f32 v150, v150
  v_exp_f32 v151, v151
  v_pk_add_f32 v[156:157], v[156:157], v[220:221] op_sel_hi:[1,0] neg_lo:[0,1] neg_hi:[0,1]
  v_pk_add_f32 v[158:159], v[158:159], v[220:221] op_sel_hi:[1,0] neg_lo:[0,1] neg_hi:[0,1]
  v_cvt_pk_bf16_f32 v192, v144, v145
  v_cvt_pk_bf16_f32 v193, v146, v147
  v_exp_f32 v152, v152
  v_exp_f32 v153, v153
  v_exp_f32 v154, v154
  v_exp_f32 v155, v155
  v_pk_add_f32 v[160:161], v[160:161], v[220:221] op_sel_hi:[1,0] neg_lo:[0,1] neg_hi:[0,1]
  v_pk_add_f32 v[162:163], v[162:163], v[220:221] op_sel_hi:[1,0] neg_lo:[0,1] neg_hi:[0,1]
  v_cvt_pk_bf16_f32 v194, v148, v149
  v_cvt_pk_bf16_f32 v195, v150, v151
  v_exp_f32 v156, v156
  v_exp_f32 v157, v157
  v_exp_f32 v158, v158
  v_exp_f32 v159, v159
  v_pk_add_f32 v[164:165], v[164:165], v[220:221] op_sel_hi:[1,0] neg_lo:[0,1] neg_hi:[0,1]
  v_pk_add_f32 v[166:167], v[166:167], v[220:221] op_sel_hi:[1,0] neg_lo:[0,1] neg_hi:[0,1]
  v_cvt_pk_bf16_f32 v196, v152, v153
  v_cvt_pk_bf16_f32 v197, v154, v155
  v_exp_f32 v160, v160
  v_exp_f32 v161, v161
  v_exp_f32 v162, v162
  v_exp_f32 v163, v163
  v_cvt_pk_bf16_f32 v198, v156, v157
  v_cvt_pk_bf16_f32 v199, v158, v159
  v_exp_f32 v164, v164
  v_exp_f32 v165, v165
  v_exp_f32 v166, v166
  v_exp_f32 v167, v167
  v_cvt_pk_bf16_f32 v200, v160, v161
  v_cvt_pk_bf16_f32 v201, v162, v163
  v_cvt_pk_bf16_f32 v202, v164, v165
  v_cvt_pk_bf16_f32 v203, v166, v167
  v_mov_b32 v168, 0
  v_mov_b32 v169, 0
  buffer_store_dwordx4 v[230:233], v2, s[8:11], s70 offen sc1
  v_mov_b32 v226, v238
  v_mov_b32 v228, v238
  v_mov_b32 v227, v239
  v_mov_b32 v229, v239
  v_permlane16_swap_b32 v226, v228
  s_nop 0
  v_permlane16_swap_b32 v227, v229
  v_lshlrev_b32 v246, 4, v10
  s_mov_b32 exec_lo, 0xffff
  s_mov_b32 exec_hi, 0x0
  buffer_store_dwordx4 v[226:229], v246, s[8:11], s71 offen sc1
  s_mov_b64 exec, -1
  s_add_u32 s70, s70, 20480
  s_add_u32 s71, s71, 20480
  v_mfma_f32_16x16x32_bf16 v[204:207], a[108:111], v[168:171], 0
  v_mfma_f32_16x16x32_bf16 v[208:211], a[144:147], v[168:171], 0
  v_mfma_f32_16x16x32_bf16 v[204:207], a[112:115], v[172:175], v[204:207]
  v_mfma_f32_16x16x32_bf16 v[208:211], a[148:151], v[172:175], v[208:211]
  v_mfma_f32_16x16x32_bf16 v[204:207], a[116:119], v[176:179], v[204:207]
  v_mfma_f32_16x16x32_bf16 v[208:211], a[152:155], v[176:179], v[208:211]
  v_mfma_f32_16x16x32_bf16 v[204:207], a[120:123], v[180:183], v[204:207]
  v_mfma_f32_16x16x32_bf16 v[208:211], a[156:159], v[180:183], v[208:211]
  v_mfma_f32_16x16x32_bf16 v[204:207], a[124:127], v[184:187], v[204:207]
  v_mfma_f32_16x16x32_bf16 v[208:211], a[160:163], v[184:187], v[208:211]
  v_mfma_f32_16x16x32_bf16 v[204:207], a[128:131], v[188:191], v[204:207]
  v_mfma_f32_16x16x32_bf16 v[208:211], a[164:167], v[188:191], v[208:211]
  v_mfma_f32_16x16x32_bf16 v[204:207], a[132:135], v[192:195], v[204:207]
  v_mfma_f32_16x16x32_bf16 v[208:211], a[168:171], v[192:195], v[208:211]
  v_mfma_f32_16x16x32_bf16 v[204:207], a[136:139], v[196:199], v[204:207]
  v_mfma_f32_16x16x32_bf16 v[208:211], a[172:175], v[196:199], v[208:211]
  v_mfma_f32_16x16x32_bf16 v[204:207], a[140:143], v[200:203], v[204:207]
  v_mfma_f32_16x16x32_bf16 v[208:211], a[176:179], v[200:203], v[208:211]
  s_nop 7
  v_mov_b32 v226, v208
  v_mov_b32 v227, v208
  s_nop 1
  v_permlane32_swap_b32 v227, v226
  v_rcp_f32 v226, v226
  s_nop 0
  v_pk_mul_f32 v[204:205], v[204:205], v[226:227] op_sel_hi:[1,0]
  v_pk_mul_f32 v[208:209], v[208:209], v[226:227] op_sel_hi:[1,0]
  v_pk_mul_f32 v[206:207], v[206:207], v[226:227] op_sel_hi:[1,0]
  v_pk_mul_f32 v[210:211], v[210:211], v[226:227] op_sel_hi:[1,0]
  v_cvt_pk_bf16_f32 v236, v204, v205
  v_cvt_pk_bf16_f32 v237, v206, v207
  v_cvt_pk_bf16_f32 v228, v208, v209
  v_cvt_pk_bf16_f32 v229, v210, v211
  v_cndmask_b32_e64 v240, v240, v228, s[44:45]
  v_cndmask_b32_e64 v241, v241, v229, s[44:45]
  buffer_store_dwordx4 v[234:237], v2, s[8:11], s70 offen sc1
  v_mov_b32 v226, v240
  v_mov_b32 v228, v240
  v_mov_b32 v227, v241
  v_mov_b32 v229, v241
  v_permlane16_swap_b32 v226, v228
  s_nop 0
  v_permlane16_swap_b32 v227, v229
  v_lshlrev_b32 v246, 4, v10
  s_mov_b32 exec_lo, 0xffff
  s_mov_b32 exec_hi, 0x0
  buffer_store_dwordx4 v[226:229], v246, s[8:11], s71 offen sc1
  s_mov_b64 exec, -1
  s_mul_i32 s60, s28, 131072
  s_add_u32 s60, s60, s84
  v_lshlrev_b32 v141, 10, v9
  v_mov_b32 v144, 1
  v_mov_b32 v145, 1
  v_mov_b32 v146, 1
  v_mov_b32 v147, 1
  s_waitcnt vmcnt(0) lgkmcnt(0)
  s_mov_b32 exec_lo, 0x10001
  s_mov_b32 exec_hi, 0x0
  buffer_store_dwordx4 v[144:147], v141, s[8:11], s60 offen sc1
  s_mov_b64 exec, -1
  s_barrier
  s_add_u32 s25, s25, 16
  s_mul_i32 s86, s28, 2621440
  s_add_u32 s36, s86, s83
  s_mul_i32 s35, s3, 13
  s_min_u32 s35, s35, 37
  s_lshl_b32 s35, s35, 10
  s_add_u32 s34, s33, s35
  s_add_u32 s34, s34, 51200
  s_mov_b32 m0, s35
  s_nop 0
  buffer_load_dwordx4 v2, s[8:11], s34 offen offset:0 lds
  buffer_load_dwordx4 v2, s[8:11], s34 offen offset:1024 lds
  buffer_load_dwordx4 v2, s[8:11], s34 offen offset:2048 lds
  buffer_load_dwordx4 v2, s[8:11], s34 offen offset:3072 lds
  s_add_u32 s35, s35, 4096
  s_add_u32 s34, s34, 4096
  s_mov_b32 m0, s35
  s_nop 0
  buffer_load_dwordx4 v2, s[8:11], s34 offen offset:0 lds
  buffer_load_dwordx4 v2, s[8:11], s34 offen offset:1024 lds
  buffer_load_dwordx4 v2, s[8:11], s34 offen offset:2048 lds
  buffer_load_dwordx4 v2, s[8:11], s34 offen offset:3072 lds
  s_add_u32 s35, s35, 4096
  s_add_u32 s34, s34, 4096
  s_mov_b32 m0, s35
  s_nop 0
  buffer_load_dwordx4 v2, s[8:11], s34 offen offset:0 lds
  buffer_load_dwordx4 v2, s[8:11], s34 offen offset:1024 lds
  buffer_load_dwordx4 v2, s[8:11], s34 offen offset:2048 lds
  buffer_load_dwordx4 v2, s[8:11], s34 offen offset:3072 lds
  s_add_u32 s35, s35, 4096
  s_add_u32 s34, s34, 4096
  s_mov_b32 m0, s35
  s_nop 0
  buffer_load_dwordx4 v2, s[8:11], s34 offen offset:0 lds
  s_mul_i32 s60, s28, 131072
  s_add_u32 s60, s60, s85
  v_lshlrev_b32 v141, 6, v10
  s_mov_b32 s62, 0
L_ow_38:
  buffer_load_dword v250, v141, s[8:11], s60 offen sc1
  s_waitcnt vmcnt(0)
  v_cmp_eq_u32 vcc, 1, v250
  s_nop 4
  s_cmp_eq_u64 vcc, -1
  s_cbranch_scc1 L_owd_39
  s_add_u32 s62, s62, 1
  s_cmp_lt_u32 s62, 400000
  s_cbranch_scc1 L_ow_38
  v_mov_b32 v140, 0xdeaf
  v_mov_b32 v141, 0
  s_mov_b32 s62, 28619264
  buffer_store_dword v140, v141, s[8:11], s62 offen sc1
L_owd_39:
  s_barrier
  buffer_load_dwordx4 a[0:3], v2, s[8:11], s36 offen offset:0 sc1
  buffer_load_dwordx4 a[4:7], v2, s[8:11], s36 offen offset:1024 sc1
  buffer_load_dwordx4 a[8:11], v2, s[8:11], s36 offen offset:2048 sc1
  buffer_load_dwordx4 a[12:15], v2, s[8:11], s36 offen offset:3072 sc1
  s_add_u32 s36, s36, 4096
  buffer_load_dwordx4 a[16:19], v2, s[8:11], s36 offen offset:0 sc1
  buffer_load_dwordx4 a[20:23], v2, s[8:11], s36 offen offset:1024 sc1
  buffer_load_dwordx4 a[24:27], v2, s[8:11], s36 offen offset:2048 sc1
  buffer_load_dwordx4 a[28:31], v2, s[8:11], s36 offen offset:3072 sc1
  s_add_u32 s36, s36, 4096
  buffer_load_dwordx4 a[32:35], v2, s[8:11], s36 offen offset:0 sc1
  buffer_load_dwordx4 a[36:39], v2, s[8:11], s36 offen offset:1024 sc1
  ds_read_b128 v[96:99], v4 offset:36864
  ds_read_b128 v[100:103], v4 offset:37888
  ds_read_b128 v[104:107], v4 offset:38912
  ds_read_b128 v[108:111], v4 offset:39936
  ds_read_b128 v[112:115], v4 offset:40960
  s_waitcnt vmcnt(9)
  s_waitcnt lgkmcnt(4)
  v_mfma_f32_16x16x32_bf16 v[32:35], v[96:99], a[0:3], 0
  ds_read_b128 v[116:119], v4 offset:41984
  s_waitcnt lgkmcnt(4)
  v_mfma_f32_16x16x32_bf16 v[36:39], v[100:103], a[0:3], 0
  ds_read_b128 v[96:99], v4 offset:43008
  buffer_load_dwordx4 a[40:43], v2, s[8:11], s36 offen offset:2048 sc1
  s_waitcnt lgkmcnt(4)
  v_mfma_f32_16x16x32_bf16 v[40:43], v[104:107], a[0:3], 0
  ds_read_b128 v[100:103], v4 offset:44032
  s_waitcnt lgkmcnt(4)
  v_mfma_f32_16x16x32_bf16 v[44:47], v[108:111], a[0:3], 0
  ds_read_b128 v[104:107], v4 offset:45056
  s_waitcnt lgkmcnt(4)
  v_mfma_f32_16x16x32_bf16 v[48:51], v[112:115], a[0:3], 0
  ds_read_b128 v[108:111], v4 offset:46080
  s_waitcnt vmcnt(9)
  s_waitcnt lgkmcnt(4)
  v_mfma_f32_16x16x32_bf16 v[32:35], v[116:119], a[4:7], v[32:35]
  ds_read_b128 v[112:115], v4 offset:47104
  s_waitcnt lgkmcnt(4)
  v_mfma_f32_16x16x32_bf16 v[36:39], v[96:99], a[4:7], v[36:39]
  ds_read_b128 v[116:119], v4 offset:48128
  buffer_load_dwordx4 a[44:47], v2, s[8:11], s36 offen offset:3072 sc1
  s_waitcnt lgkmcnt(4)
  v_mfma_f32_16x16x32_bf16 v[40:43], v[100:103], a[4:7], v[40:43]
  ds_read_b128 v[96:99], v4 offset:49152
  s_waitcnt lgkmcnt(4)
  v_mfma_f32_16x16x32_bf16 v[44:47], v[104:107], a[4:7], v[44:47]
  ds_read_b128 v[100:103], v4 offset:50176
  s_waitcnt lgkmcnt(4)
  v_mfma_f32_16x16x32_bf16 v[48:51], v[108:111], a[4:7], v[48:51]
  ds_read_b128 v[104:107], v4 offset:51200
  s_waitcnt vmcnt(9)
  s_waitcnt lgkmcnt(4)
  v_mfma_f32_16x16x32_bf16 v[32:35], v[112:115], a[8:11], v[32:35]
  ds_read_b128 v[108:111], v4 offset:52224
  s_waitcnt lgkmcnt(4)
  v_mfma_f32_16x16x32_bf16 v[36:39], v[116:119], a[8:11], v[36:39]
  ds_read_b128 v[112:115], v4 offset:53248
  s_add_u32 s36, s36, 4096
  buffer_load_dwordx4 a[48:51], v2, s[8:11], s36 offen offset:0 sc1
  s_waitcnt lgkmcnt(4)
  v_mfma_f32_16x16x32_bf16 v[40:43], v[96:99], a[8:11], v[40:43]
  ds_read_b128 v[116:119], v4 offset:54272
  s_waitcnt lgkmcnt(4)
  v_mfma_f32_16x16x32_bf16 v[44:47], v[100:103], a[8:11], v[44:47]
  ds_read_b128 v[96:99], v4 offset:55296
  s_waitcnt lgkmcnt(4)
  v_mfma_f32_16x16x32_bf16 v[48:51], v[104:107], a[8:11], v[48:51]
  ds_read_b128 v[100:103], v4 offset:56320
  s_waitcnt vmcnt(9)
  s_waitcnt lgkmcnt(4)
  v_mfma_f32_16x16x32_bf16 v[32:35], v[108:111], a[12:15], v[32:35]
  ds_read_b128 v[104:107], v4 offset:57344
  s_waitcnt lgkmcnt(4)
  v_mfma_f32_16x16x32_bf16 v[36:39], v[112:115], a[12:15], v[36:39]
  ds_read_b128 v[108:111], v4 offset:58368
  buffer_load_dwordx4 a[52:55], v2, s[8:11], s36 offen offset:1024 sc1
  s_waitcnt lgkmcnt(4)
  v_mfma_f32_16x16x32_bf16 v[40:43], v[116:119], a[12:15], v[40:43]
  ds_read_b128 v[112:115], v4 offset:59392
  s_waitcnt lgkmcnt(4)
  v_mfma_f32_16x16x32_bf16 v[44:47], v[96:99], a[12:15], v[44:47]
  ds_read_b128 v[116:119], v4 offset:60416
  s_waitcnt lgkmcnt(4)
  v_mfma_f32_16x16x32_bf16 v[48:51], v[100:103], a[12:15], v[48:51]
  ds_read_b128 v[96:99], v4 offset:61440
  s_waitcnt vmcnt(9)
  s_waitcnt lgkmcnt(4)
  v_mfma_f32_16x16x32_bf16 v[32:35], v[104:107], a[16:19], v[32:35]
  ds_read_b128 v[100:103], v4 offset:62464
  s_waitcnt lgkmcnt(4)
  v_mfma_f32_16x16x32_bf16 v[36:39], v[108:111], a[16:19], v[36:39]
  ds_read_b128 v[104:107], v4 offset:63488
  buffer_load_dwordx4 a[56:59], v2, s[8:11], s36 offen offset:2048 sc1
  s_waitcnt lgkmcnt(4)
  v_mfma_f32_16x16x32_bf16 v[40:43], v[112:115], a[16:19], v[40:43]
  ds_read_b128 v[108:111], v4 offset:64512
  s_waitcnt lgkmcnt(4)
  v_mfma_f32_16x16x32_bf16 v[44:47], v[116:119], a[16:19], v[44:47]
  ds_read_b128 v[112:115], v5 offset:0
  s_waitcnt lgkmcnt(4)
  v_mfma_f32_16x16x32_bf16 v[48:51], v[96:99], a[16:19], v[48:51]
  ds_read_b128 v[116:119], v5 offset:1024
  s_waitcnt vmcnt(9)
  s_waitcnt lgkmcnt(4)
  v_mfma_f32_16x16x32_bf16 v[32:35], v[100:103], a[20:23], v[32:35]
  ds_read_b128 v[96:99], v5 offset:2048
  s_waitcnt lgkmcnt(4)
  v_mfma_f32_16x16x32_bf16 v[36:39], v[104:107], a[20:23], v[36:39]
  ds_read_b128 v[100:103], v5 offset:3072
  buffer_load_dwordx4 a[60:63], v2, s[8:11], s36 offen offset:3072 sc1
  s_waitcnt lgkmcnt(4)
  v_mfma_f32_16x16x32_bf16 v[40:43], v[108:111], a[20:23], v[40:43]
  ds_read_b128 v[104:107], v5 offset:4096
  s_waitcnt lgkmcnt(4)
  v_mfma_f32_16x16x32_bf16 v[44:47], v[112:115], a[20:23], v[44:47]
  ds_read_b128 v[108:111], v5 offset:5120
  s_waitcnt lgkmcnt(4)
  v_mfma_f32_16x16x32_bf16 v[48:51], v[116:119], a[20:23], v[48:51]
  ds_read_b128 v[112:115], v5 offset:6144
  s_waitcnt vmcnt(9)
  s_waitcnt lgkmcnt(4)
  v_mfma_f32_16x16x32_bf16 v[32:35], v[96:99], a[24:27], v[32:35]
  ds_read_b128 v[116:119], v5 offset:7168
  s_waitcnt lgkmcnt(4)
  v_mfma_f32_16x16x32_bf16 v[36:39], v[100:103], a[24:27], v[36:39]
  ds_read_b128 v[96:99], v5 offset:8192
  s_add_u32 s36, s36, 4096
  buffer_load_dwordx4 a[64:67], v2, s[8:11], s36 offen offset:0 sc1
  s_waitcnt lgkmcnt(4)
  v_mfma_f32_16x16x32_bf16 v[40:43], v[104:107], a[24:27], v[40:43]
  ds_read_b128 v[100:103], v5 offset:9216
  s_waitcnt lgkmcnt(4)
  v_mfma_f32_16x16x32_bf16 v[44:47], v[108:111], a[24:27], v[44:47]
  ds_read_b128 v[104:107], v5 offset:10240
  s_waitcnt lgkmcnt(4)
  v_mfma_f32_16x16x32_bf16 v[48:51], v[112:115], a[24:27], v[48:51]
  ds_read_b128 v[108:111], v5 offset:11264
  s_waitcnt vmcnt(9)
  s_waitcnt lgkmcnt(4)
  v_mfma_f32_16x16x32_bf16 v[32:35], v[116:119], a[28:31], v[32:35]
  ds_read_b128 v[112:115], v5 offset:12288
  s_waitcnt lgkmcnt(4)
  v_mfma_f32_16x16x32_bf16 v[36:39], v[96:99], a[28:31], v[36:39]
  ds_read_b128 v[116:119], v5 offset:13312
  buffer_load_dwordx4 a[68:71], v2, s[8:11], s36 offen offset:1024 sc1
  s_waitcnt lgkmcnt(4)
  v_mfma_f32_16x16x32_bf16 v[40:43], v[100:103], a[28:31], v[40:43]
  ds_read_b128 v[96:99], v5 offset:14336
  s_waitcnt lgkmcnt(4)
  v_mfma_f32_16x16x32_bf16 v[44:47], v[104:107], a[28:31], v[44:47]
  ds_read_b128 v[100:103], v5 offset:15360
  s_waitcnt lgkmcnt(4)
  v_mfma_f32_16x16x32_bf16 v[48:51], v[108:111], a[28:31], v[48:51]
  ds_read_b128 v[104:107], v5 offset:16384
  s_waitcnt vmcnt(9)
  s_waitcnt lgkmcnt(4)
  v_mfma_f32_16x16x32_bf16 v[32:35], v[112:115], a[32:35], v[32:35]
  ds_read_b128 v[108:111], v5 offset:17408
  s_waitcnt lgkmcnt(4)
  v_mfma_f32_16x16x32_bf16 v[36:39], v[116:119], a[32:35], v[36:39]
  ds_read_b128 v[112:115], v5 offset:18432
  buffer_load_dwordx4 a[72:75], v2, s[8:11], s36 offen offset:2048 sc1
  s_waitcnt lgkmcnt(4)
  v_mfma_f32_16x16x32_bf16 v[40:43], v[96:99], a[32:35], v[40:43]
  ds_read_b128 v[116:119], v5 offset:19456
  s_waitcnt lgkmcnt(4)
  v_mfma_f32_16x16x32_bf16 v[44:47], v[100:103], a[32:35], v[44:47]
  ds_read_b128 v[96:99], v5 offset:20480
  s_waitcnt lgkmcnt(4)
  v_mfma_f32_16x16x32_bf16 v[48:51], v[104:107], a[32:35], v[48:51]
  ds_read_b128 v[100:103], v5 offset:21504
  s_waitcnt vmcnt(9)
  s_waitcnt lgkmcnt(4)
  v_mfma_f32_16x16x32_bf16 v[32:35], v[108:111], a[36:39], v[32:35]
  ds_read_b128 v[104:107], v3 offset:0
  s_waitcnt lgkmcnt(4)
  v_mfma_f32_16x16x32_bf16 v[36:39], v[112:115], a[36:39], v[36:39]
  ds_read_b128 v[108:111], v3 offset:1024
  buffer_load_dwordx4 a[76:79], v2, s[8:11], s36 offen offset:3072 sc1
  s_mul_i32 s35, s3, 13
  s_min_u32 s35, s35, 37
  s_lshl_b32 s35, s35, 10
  s_add_u32 s34, s30, s35
  s_add_u32 s35, s35, 51200
  s_mov_b32 m0, s35
  s_nop 0
  buffer_load_dwordx4 v2, s[8:11], s34 offen offset:0 lds
  s_waitcnt lgkmcnt(4)
  v_mfma_f32_16x16x32_bf16 v[40:43], v[116:119], a[36:39], v[40:43]
  ds_read_b128 v[112:115], v3 offset:2048
  s_waitcnt lgkmcnt(4)
  v_mfma_f32_16x16x32_bf16 v[44:47], v[96:99], a[36:39], v[44:47]
  ds_read_b128 v[116:119], v3 offset:3072
  s_waitcnt lgkmcnt(4)
  v_mfma_f32_16x16x32_bf16 v[48:51], v[100:103], a[36:39], v[48:51]
  ds_read_b128 v[96:99], v3 offset:4096
  s_waitcnt vmcnt(10)
  s_waitcnt lgkmcnt(4)
  v_mfma_f32_16x16x32_bf16 v[32:35], v[104:107], a[40:43], v[32:35]
  ds_read_b128 v[100:103], v3 offset:5120
  buffer_load_dwordx4 v2, s[8:11], s34 offen offset:1024 lds
  s_waitcnt lgkmcnt(4)
  v_mfma_f32_16x16x32_bf16 v[36:39], v[108:111], a[40:43], v[36:39]
  ds_read_b128 v[104:107], v3 offset:6144
  s_waitcnt lgkmcnt(4)
  v_mfma_f32_16x16x32_bf16 v[40:43], v[112:115], a[40:43], v[40:43]
  ds_read_b128 v[108:111], v3 offset:7168
  s_waitcnt lgkmcnt(4)
  v_mfma_f32_16x16x32_bf16 v[44:47], v[116:119], a[40:43], v[44:47]
  ds_read_b128 v[112:115], v3 offset:8192
  s_waitcnt lgkmcnt(4)
  v_mfma_f32_16x16x32_bf16 v[48:51], v[96:99], a[40:43], v[48:51]
  ds_read_b128 v[116:119], v3 offset:9216
  buffer_load_dwordx4 v2, s[8:11], s34 offen offset:2048 lds
  s_waitcnt vmcnt(11)
  s_waitcnt lgkmcnt(4)
  v_mfma_f32_16x16x32_bf16 v[32:35], v[100:103], a[44:47], v[32:35]
  ds_read_b128 v[96:99], v3 offset:10240
  s_waitcnt lgkmcnt(4)
  v_mfma_f32_16x16x32_bf16 v[36:39], v[104:107], a[44:47], v[36:39]
  ds_read_b128 v[100:103], v3 offset:11264
  s_waitcnt lgkmcnt(4)
  v_mfma_f32_16x16x32_bf16 v[40:43], v[108:111], a[44:47], v[40:43]
  ds_read_b128 v[104:107], v3 offset:12288
  s_waitcnt lgkmcnt(4)
  v_mfma_f32_16x16x32_bf16 v[44:47], v[112:115], a[44:47], v[44:47]
  ds_read_b128 v[108:111], v3 offset:13312
  buffer_load_dwordx4 v2, s[8:11], s34 offen offset:3072 lds
  s_waitcnt lgkmcnt(4)
  v_mfma_f32_16x16x32_bf16 v[48:51], v[116:119], a[44:47], v[48:51]
  ds_read_b128 v[112:115], v3 offset:14336
  s_waitcnt vmcnt(11)
  s_waitcnt lgkmcnt(4)
  v_mfma_f32_16x16x32_bf16 v[32:35], v[96:99], a[48:51], v[32:35]
  ds_read_b128 v[116:119], v3 offset:15360
  s_waitcnt lgkmcnt(4)
  v_mfma_f32_16x16x32_bf16 v[36:39], v[100:103], a[48:51], v[36:39]
  ds_read_b128 v[96:99], v3 offset:16384
  s_waitcnt lgkmcnt(4)
  v_mfma_f32_16x16x32_bf16 v[40:43], v[104:107], a[48:51], v[40:43]
  ds_read_b128 v[100:103], v3 offset:17408
  s_add_u32 s35, s35, 4096
  s_add_u32 s34, s34, 4096
  s_mov_b32 m0, s35
  s_nop 0
  buffer_load_dwordx4 v2, s[8:11], s34 offen offset:0 lds
  s_waitcnt lgkmcnt(4)
  v_mfma_f32_16x16x32_bf16 v[44:47], v[108:111], a[48:51], v[44:47]
  ds_read_b128 v[104:107], v3 offset:18432
  s_waitcnt lgkmcnt(4)
  v_mfma_f32_16x16x32_bf16 v[48:51], v[112:115], a[48:51], v[48:51]
  ds_read_b128 v[108:111], v3 offset:19456
  s_waitcnt vmcnt(11)
  s_waitcnt lgkmcnt(4)
  v_mfma_f32_16x16x32_bf16 v[32:35], v[116:119], a[52:55], v[32:35]
  ds_read_b128 v[112:115], v3 offset:20480
  s_waitcnt lgkmcnt(4)
  v_mfma_f32_16x16x32_bf16 v[36:39], v[96:99], a[52:55], v[36:39]
  ds_read_b128 v[116:119], v3 offset:21504
  buffer_load_dwordx4 v2, s[8:11], s34 offen offset:1024 lds
  s_waitcnt lgkmcnt(4)
  v_mfma_f32_16x16x32_bf16 v[40:43], v[100:103], a[52:55], v[40:43]
  ds_read_b128 v[96:99], v3 offset:22528
  s_waitcnt lgkmcnt(4)
  v_mfma_f32_16x16x32_bf16 v[44:47], v[104:107], a[52:55], v[44:47]
  ds_read_b128 v[100:103], v3 offset:23552
  s_waitcnt lgkmcnt(4)
  v_mfma_f32_16x16x32_bf16 v[48:51], v[108:111], a[52:55], v[48:51]
  ds_read_b128 v[104:107], v3 offset:24576
  s_waitcnt vmcnt(11)
  s_waitcnt lgkmcnt(4)
  v_mfma_f32_16x16x32_bf16 v[32:35], v[112:115], a[56:59], v[32:35]
  ds_read_b128 v[108:111], v3 offset:25600
  buffer_load_dwordx4 v2, s[8:11], s34 offen offset:2048 lds
  s_waitcnt lgkmcnt(4)
  v_mfma_f32_16x16x32_bf16 v[36:39], v[116:119], a[56:59], v[36:39]
  ds_read_b128 v[112:115], v3 offset:26624
  s_waitcnt lgkmcnt(4)
  v_mfma_f32_16x16x32_bf16 v[40:43], v[96:99], a[56:59], v[40:43]
  ds_read_b128 v[116:119], v3 offset:27648
  s_waitcnt lgkmcnt(4)
  v_mfma_f32_16x16x32_bf16 v[44:47], v[100:103], a[56:59], v[44:47]
  ds_read_b128 v[96:99], v3 offset:28672
  s_waitcnt lgkmcnt(4)
  v_mfma_f32_16x16x32_bf16 v[48:51], v[104:107], a[56:59], v[48:51]
  ds_read_b128 v[100:103], v3 offset:29696
  buffer_load_dwordx4 v2, s[8:11], s34 offen offset:3072 lds
  s_waitcnt vmcnt(12)
  s_waitcnt lgkmcnt(4)
  v_mfma_f32_16x16x32_bf16 v[32:35], v[108:111], a[60:63], v[32:35]
  ds_read_b128 v[104:107], v3 offset:30720
  s_waitcnt lgkmcnt(4)
  v_mfma_f32_16x16x32_bf16 v[36:39], v[112:115], a[60:63], v[36:39]
  ds_read_b128 v[108:111], v3 offset:31744
  s_waitcnt lgkmcnt(4)
  v_mfma_f32_16x16x32_bf16 v[40:43], v[116:119], a[60:63], v[40:43]
  ds_read_b128 v[112:115], v3 offset:32768
  s_waitcnt lgkmcnt(4)
  v_mfma_f32_16x16x32_bf16 v[44:47], v[96:99], a[60:63], v[44:47]
  ds_read_b128 v[116:119], v3 offset:33792
  s_add_u32 s35, s35, 4096
  s_add_u32 s34, s34, 4096
  s_mov_b32 m0, s35
  s_nop 0
  buffer_load_dwordx4 v2, s[8:11], s34 offen offset:0 lds
  s_waitcnt lgkmcnt(4)
  v_mfma_f32_16x16x32_bf16 v[48:51], v[100:103], a[60:63], v[48:51]
  ds_read_b128 v[96:99], v3 offset:34816
  s_waitcnt vmcnt(12)
  s_waitcnt lgkmcnt(4)
  v_mfma_f32_16x16x32_bf16 v[32:35], v[104:107], a[64:67], v[32:35]
  ds_read_b128 v[100:103], v3 offset:35840
  s_waitcnt lgkmcnt(4)
  v_mfma_f32_16x16x32_bf16 v[36:39], v[108:111], a[64:67], v[36:39]
  ds_read_b128 v[104:107], v3 offset:36864
  s_waitcnt lgkmcnt(4)
  v_mfma_f32_16x16x32_bf16 v[40:43], v[112:115], a[64:67], v[40:43]
  ds_read_b128 v[108:111], v3 offset:37888
  buffer_load_dwordx4 v2, s[8:11], s34 offen offset:1024 lds
  s_waitcnt lgkmcnt(4)
  v_mfma_f32_16x16x32_bf16 v[44:47], v[116:119], a[64:67], v[44:47]
  ds_read_b128 v[112:115], v3 offset:38912
  s_waitcnt lgkmcnt(4)
  v_mfma_f32_16x16x32_bf16 v[48:51], v[96:99], a[64:67], v[48:51]
  ds_read_b128 v[116:119], v3 offset:39936
  s_waitcnt vmcnt(12)
  s_waitcnt lgkmcnt(4)
  v_mfma_f32_16x16x32_bf16 v[32:35], v[100:103], a[68:71], v[32:35]
  ds_read_b128 v[96:99], v3 offset:40960
  s_waitcnt lgkmcnt(4)
  v_mfma_f32_16x16x32_bf16 v[36:39], v[104:107], a[68:71], v[36:39]
  ds_read_b128 v[100:103], v3 offset:41984
  buffer_load_dwordx4 v2, s[8:11], s34 offen offset:2048 lds
  s_waitcnt lgkmcnt(4)
  v_mfma_f32_16x16x32_bf16 v[40:43], v[108:111], a[68:71], v[40:43]
  ds_read_b128 v[104:107], v3 offset:43008
  s_waitcnt lgkmcnt(4)
  v_mfma_f32_16x16x32_bf16 v[44:47], v[112:115], a[68:71], v[44:47]
  ds_read_b128 v[108:111], v3 offset:44032
  s_waitcnt lgkmcnt(4)
  v_mfma_f32_16x16x32_bf16 v[48:51], v[116:119], a[68:71], v[48:51]
  ds_read_b128 v[112:115], v3 offset:45056
  s_waitcnt vmcnt(12)
  s_waitcnt lgkmcnt(4)
  v_mfma_f32_16x16x32_bf16 v[32:35], v[96:99], a[72:75], v[32:35]
  ds_read_b128 v[116:119], v3 offset:46080
  buffer_load_dwordx4 v2, s[8:11], s34 offen offset:3072 lds
  s_waitcnt lgkmcnt(4)
  v_mfma_f32_16x16x32_bf16 v[36:39], v[100:103], a[72:75], v[36:39]
  ds_read_b128 v[96:99], v3 offset:47104
  s_waitcnt lgkmcnt(4)
  v_mfma_f32_16x16x32_bf16 v[40:43], v[104:107], a[72:75], v[40:43]
  ds_read_b128 v[100:103], v3 offset:48128
  s_waitcnt lgkmcnt(4)
  v_mfma_f32_16x16x32_bf16 v[44:47], v[108:111], a[72:75], v[44:47]
  ds_read_b128 v[104:107], v3 offset:49152
  s_waitcnt lgkmcnt(4)
  v_mfma_f32_16x16x32_bf16 v[48:51], v[112:115], a[72:75], v[48:51]
  ds_read_b128 v[108:111], v3 offset:50176
  s_add_u32 s35, s35, 4096
  s_add_u32 s34, s34, 4096
  s_mov_b32 m0, s35
  s_nop 0
  buffer_load_dwordx4 v2, s[8:11], s34 offen offset:0 lds
  s_waitcnt vmcnt(13)
  s_waitcnt lgkmcnt(4)
  v_mfma_f32_16x16x32_bf16 v[32:35], v[116:119], a[76:79], v[32:35]
  s_waitcnt lgkmcnt(3)
  v_mfma_f32_16x16x32_bf16 v[36:39], v[96:99], a[76:79], v[36:39]
  s_waitcnt lgkmcnt(2)
  v_mfma_f32_16x16x32_bf16 v[40:43], v[100:103], a[76:79], v[40:43]
  s_waitcnt lgkmcnt(1)
  v_mfma_f32_16x16x32_bf16 v[44:47], v[104:107], a[76:79], v[44:47]
  s_waitcnt lgkmcnt(0)
  v_mfma_f32_16x16x32_bf16 v[48:51], v[108:111], a[76:79], v[48:51]
  v_pk_add_f32 v[32:33], v[32:33], v[12:13]
  v_pk_add_f32 v[34:35], v[34:35], v[14:15]
  v_pk_add_f32 v[36:37], v[36:37], v[16:17]
  v_pk_add_f32 v[38:39], v[38:39], v[18:19]
  v_pk_add_f32 v[40:41], v[40:41], v[20:21]
  v_pk_add_f32 v[42:43], v[42:43], v[22:23]
  v_pk_add_f32 v[44:45], v[44:45], v[24:25]
  v_pk_add_f32 v[46:47], v[46:47], v[26:27]
  v_pk_add_f32 v[48:49], v[48:49], v[28:29]
  v_pk_add_f32 v[50:51], v[50:51], v[30:31]
  v_cvt_pk_bf16_f32 v144, v32, v33
  v_cvt_pk_bf16_f32 v145, v34, v35
  v_cvt_pk_bf16_f32 v146, v36, v37
  v_cvt_pk_bf16_f32 v147, v38, v39
  v_cvt_pk_bf16_f32 v148, v40, v41
  v_cvt_pk_bf16_f32 v149, v42, v43
  v_cvt_pk_bf16_f32 v150, v44, v45
  v_cvt_pk_bf16_f32 v151, v46, v47
  v_cvt_pk_bf16_f32 v152, v48, v49
  v_cvt_pk_bf16_f32 v153, v50, v51
  s_cmp_eq_u32 s24, 1
  s_cbranch_scc1 L_o_final_40
  s_add_u32 s61, s86, s80
  s_mov_b32 s70, s61
  buffer_store_dwordx4 v[144:147], v2, s[8:11], s61 offen sc1
  buffer_store_dwordx4 v[148:151], v2, s[8:11], s61 offen offset:1024 sc1
  s_add_u32 s61, s86, s81
  v_lshrrev_b32 v141, 1, v9
  v_lshlrev_b32 v141, 8, v141
  v_lshl_add_u32 v141, v10, 4, v141
  v_mov_b32 v172, v152
  v_mov_b32 v174, v152
  v_mov_b32 v173, v153
  v_mov_b32 v175, v153
  v_permlane16_swap_b32 v172, v174
  s_nop 0
  v_permlane16_swap_b32 v173, v175
  s_mov_b32 exec_lo, 0xffff
  s_mov_b32 exec_hi, 0xffff
  buffer_store_dwordx4 v[172:175], v141, s[8:11], s61 offen sc1
  s_mov_b64 exec, -1
  s_mov_b32 s71, s61
  v_mov_b32 v170, v141
  v_lshlrev_b32 v12, 16, v144
  v_and_b32 v13, 0xffff0000, v144
  v_lshlrev_b32 v14, 16, v145
  v_and_b32 v15, 0xffff0000, v145
  v_lshlrev_b32 v16, 16, v146
  v_and_b32 v17, 0xffff0000, v146
  v_lshlrev_b32 v18, 16, v147
  v_and_b32 v19, 0xffff0000, v147
  v_lshlrev_b32 v20, 16, v148
  v_and_b32 v21, 0xffff0000, v148
  v_lshlrev_b32 v22, 16, v149
  v_and_b32 v23, 0xffff0000, v149
  v_lshlrev_b32 v24, 16, v150
  v_and_b32 v25, 0xffff0000, v150
  v_lshlrev_b32 v26, 16, v151
  v_and_b32 v27, 0xffff0000, v151
  v_lshlrev_b32 v28, 16, v152
  v_and_b32 v29, 0xffff0000, v152
  v_lshlrev_b32 v30, 16, v153
  v_and_b32 v31, 0xffff0000, v153
  v_pk_add_f32 v[156:157], v[12:13], v[14:15]
  v_pk_mul_f32 v[158:159], v[12:13], v[12:13]
  v_pk_fma_f32 v[158:159], v[14:15], v[14:15], v[158:159]
  v_pk_add_f32 v[156:157], v[156:157], v[16:17]
  v_pk_fma_f32 v[158:159], v[16:17], v[16:17], v[158:159]
  v_pk_add_f32 v[156:157], v[156:157], v[18:19]
  v_pk_fma_f32 v[158:159], v[18:19], v[18:19], v[158:159]
  v_pk_add_f32 v[156:157], v[156:157], v[20:21]
  v_pk_fma_f32 v[158:159], v[20:21], v[20:21], v[158:159]
  v_pk_add_f32 v[156:157], v[156:157], v[22:23]
  v_pk_fma_f32 v[158:159], v[22:23], v[22:23], v[158:159]
  v_pk_add_f32 v[156:157], v[156:157], v[24:25]
  v_pk_fma_f32 v[158:159], v[24:25], v[24:25], v[158:159]
  v_pk_add_f32 v[156:157], v[156:157], v[26:27]
  v_pk_fma_f32 v[158:159], v[26:27], v[26:27], v[158:159]
  v_pk_add_f32 v[156:157], v[156:157], v[28:29]
  v_pk_fma_f32 v[158:159], v[28:29], v[28:29], v[158:159]
  v_pk_add_f32 v[156:157], v[156:157], v[30:31]
  v_pk_fma_f32 v[158:159], v[30:31], v[30:31], v[158:159]
  v_add_f32 v156, v156, v157
  v_add_f32 v157, v158, v159
  v_mov_b32 v160, v156
  v_mov_b32 v161, v157
  s_nop 0
  v_permlane32_swap_b32 v156, v160
  v_permlane32_swap_b32 v157, v161
  v_add_f32 v156, v156, v160
  v_add_f32 v157, v157, v161
  v_mov_b32 v160, v156
  v_mov_b32 v161, v157
  s_nop 0
  v_permlane16_swap_b32 v156, v160
  v_permlane16_swap_b32 v157, v161
  v_add_f32 v156, v156, v160
  v_add_f32 v157, v157, v161
  s_mul_i32 s60, s28, 131072
  s_add_u32 s60, s60, s82
  v_lshlrev_b32 v141, 3, v10
  v_mov_b32_dpp v158, v156 quad_perm:[1,0,3,2] row_mask:0xf bank_mask:0xf
  v_mov_b32_dpp v159, v157 quad_perm:[1,0,3,2] row_mask:0xf bank_mask:0xf
  s_waitcnt vmcnt(0) lgkmcnt(0)
  s_mov_b32 exec_lo, 0x5555
  s_mov_b32 exec_hi, 0x0
  buffer_store_dwordx4 v[156:159], v141, s[8:11], s60 offen sc1
  s_mov_b64 exec, -1
  s_barrier
  s_add_u32 s25, s25, 16
  s_branch L_o_done_41
L_o_final_40:
  s_mul_i32 s60, s67, 20480
  s_mul_i32 s61, s22, 160
  s_add_u32 s60, s60, s61
  v_mul_u32_u24 v141, 1280, v10
  v_lshl_add_u32 v142, v9, 4, v141
  v_lshl_add_u32 v143, v9, 3, v141
  buffer_store_dwordx4 v[144:147], v142, s[16:19], s60 offen
  buffer_store_dwordx4 v[148:151], v142, s[16:19], s60 offen offset:64
  buffer_store_dwordx2 v[152:153], v143, s[16:19], s60 offen offset:128
  s_endpgm
L_o_done_41:
  s_add_u32 s24, s24, 1
  s_branch MAIN_loop
MAIN_end:
  s_endpgm
.section .rodata,"a"
.p2align 6
.amdhsa_kernel prep_kernel
  .amdhsa_next_free_vgpr 160
  .amdhsa_next_free_sgpr 96
  .amdhsa_accum_offset 160
  .amdhsa_group_segment_fixed_size 0
  .amdhsa_kernarg_size 72
  .amdhsa_user_sgpr_count 2
  .amdhsa_user_sgpr_kernarg_segment_ptr 1
  .amdhsa_system_sgpr_workgroup_id_x 1
  .amdhsa_float_denorm_mode_32 3
.end_amdhsa_kernel
.p2align 6
.amdhsa_kernel main_kernel
  .amdhsa_next_free_vgpr 512
  .amdhsa_next_free_sgpr 102
  .amdhsa_accum_offset 256
  .amdhsa_group_segment_fixed_size 0
  .amdhsa_kernarg_size 72
  .amdhsa_user_sgpr_count 2
  .amdhsa_user_sgpr_kernarg_segment_ptr 1
  .amdhsa_system_sgpr_workgroup_id_x 1
  .amdhsa_float_denorm_mode_32 3
.end_amdhsa_kernel
```
